```python
import torch

def _softmax(x, axis=-1):
    return torch.softmax(x, dim=axis)
def _gelu(x):
    return torch.nn.functional.gelu(x, approximate="tanh")
def _silu(x):
    return torch.nn.functional.silu(x)
def _sigmoid(x):
    return torch.sigmoid(x)
def _layernorm(x, axis=-1, eps=1e-5):
    m = x.mean(dim=axis, keepdim=True)
    v = x.var(dim=axis, keepdim=True, unbiased=False)
    return (x - m) / torch.sqrt(v + eps)
def _scatter_add(tgt, idx, src, axis=0):
    return tgt.clone().index_add_(axis, idx, src)
def _segment_sum(src, seg, n):
    out = torch.zeros((n,) + src.shape[1:], dtype=src.dtype)
    return out.index_add_(0, seg, src)
def _pad(x, pw):
    flat = tuple(v for pair in reversed(pw) for v in pair)
    return torch.nn.functional.pad(x, flat)

kernel_name = 'gather_scatter__edge_featured_mpnn_egc__graph'

def setup_inputs():

    _w = (lambda a: (lambda t: t.to(torch.bfloat16) if t.is_floating_point() else t)(torch.as_tensor(a)))
    N, deg, D, De = 50000, 16, 64, max(16, 1)
    E = N * deg
    return {
        "x": _w((lambda *s: torch.randn(*s, dtype=torch.bfloat16) * 0.2)(N, D)),
        "e_attr": _w((lambda *s: torch.randn(*s, dtype=torch.bfloat16) * 0.2)(E, De)),
        "src": _w((lambda lo, hi, *s: torch.randint(lo, hi, s))(0, N, E).to(torch.int64)),
        "dst": _w((lambda lo, hi, *s: torch.randint(lo, hi, s))(0, N, E).to(torch.int64)),
        "u_w": _w((lambda *s: torch.randn(*s, dtype=torch.bfloat16) * 0.05)(D, D)),
        "v_w": _w((lambda *s: torch.randn(*s, dtype=torch.bfloat16) * 0.05)(D, D)),
        "g_w": _w((lambda *s: torch.randn(*s, dtype=torch.bfloat16) * 0.2)(2 * D + De, D)),
    }

def reference(x, e_attr, src, dst, u_w, v_w, g_w):
    N, D = x.shape
    g_in = torch.concatenate([x[dst], x[src], e_attr], axis=-1)
    eta = _sigmoid(g_in @ g_w)
    hv = x @ v_w
    msg = eta * hv[src]
    agg = _segment_sum(msg, dst, N)
    return _silu(x @ u_w + agg)
```

```asm
; @launch grid=(256,1,1) block=(512,1,1) lds=163840
.amdgcn_target "amdgcn-amd-amdhsa--gfx950"
.text
.globl gather_scatter__edge_featured_mpnn_egc__graph_kernel
.p2align 12
.p2align 8
.type gather_scatter__edge_featured_mpnn_egc__graph_kernel,@function
gather_scatter__edge_featured_mpnn_egc__graph_kernel:
    s_cmp_ge_u32 s2, 256
    s_cbranch_scc1 M_end
    s_load_dwordx16 s[40:55], s[0:1], 0
    s_load_dwordx4 s[56:59], s[0:1], 64
    s_getpc_b64 s[10:11]
M_pc:
    v_lshlrev_b32 v133, 6, v0
    v_min_u32 v133, M_last-M_pc-4, v133
    global_load_dword v133, v133, s[10:11]
    v_mov_b32 v239, v0
    v_lshrrev_b32 v240, 6, v0
    s_and_b32 s10, s2, 7
    s_lshr_b32 s11, s2, 3
    v_readfirstlane_b32 s28, v240
    s_lshl_b32 s3, s10, 5
    s_add_u32 s3, s3, s11
    s_and_b32 s34, s11, 0x18
    s_add_u32 s34, s34, s10
    s_lshl_b32 s34, s34, 3
    s_and_b32 s11, s11, 7
    s_add_u32 s34, s34, s11
    s_mul_i32 s72, s34, 12512
    s_add_u32 s73, s72, 12512
    s_min_u32 s73, s73, 3200000
    s_add_u32 s74, s72, 8192
    s_add_u32 s75, s72, 12288
    v_lshlrev_b32 v130, 4, v0
    v_lshlrev_b32 v131, 3, v0
    v_lshlrev_b32 v132, 2, v0
    v_and_b32 v241, 63, v0
    v_and_b32 v242, 31, v0
    v_lshrrev_b32 v243, 5, v241
    v_lshlrev_b32 v245, 4, v243
    s_and_b32 s10, s28, 3
    s_lshr_b32 s11, s28, 2
    s_lshl_b32 s29, s10, 1
    s_add_u32 s29, s29, s11
    s_xor_b32 s29, s29, 1
    s_lshl_b32 s38, s3, 2
    s_add_u32 s38, s10, s38
    s_mul_i32 s38, s38, 49
    s_mul_i32 s11, s11, 25
    s_add_u32 s36, s38, s11
    s_lshl_b32 s38, s28, 11
    s_lshl_b32 s39, s10, 11
    v_mov_b32 v134, 4
    s_cmp_eq_u32 s28, 1
    s_cbranch_scc1 M_pp0
    s_cmp_eq_u32 s28, 2
    s_cbranch_scc1 M_pp1
    s_cmp_eq_u32 s28, 3
    s_cbranch_scc1 M_pp2
    s_cmp_eq_u32 s28, 4
    s_cbranch_scc1 M_hop_r
M_pback:
    s_waitcnt lgkmcnt(0)
    s_mov_b32 s60, s46
    s_mov_b32 s61, s47
    s_mov_b32 s62, s73
    s_mov_b32 s63, 0x20000
    s_mov_b32 s64, s44
    s_mov_b32 s65, s45
    s_mov_b32 s66, s73
    s_mov_b32 s67, 0x20000
    buffer_load_dwordx4 v[88:91], v130, s[60:63], s72 offen
    buffer_load_dwordx4 v[96:99], v130, s[64:67], s72 offen
    buffer_load_dwordx2 v[92:93], v131, s[60:63], s74 offen
    buffer_load_dwordx2 v[100:101], v131, s[64:67], s74 offen
    buffer_load_dword v94, v132, s[60:63], s75 offen
    buffer_load_dword v102, v132, s[64:67], s75 offen
    s_mov_b32 s20, s58
    s_mov_b32 s21, s59
    s_mov_b32 s22, 17825792
    s_mov_b32 s23, 0x20000
    buffer_load_dword v238, v134, s[20:23], 0 offen
    v_mov_b32 v136, 65535
    v_mov_b32 v137, 65535
    v_mov_b32 v138, 65535
    v_mov_b32 v139, 0
    v_lshrrev_b32 v134, 4, v0
    v_mul_u32_u24 v134, 16, v134
    v_add_u32 v134, v134, v130
    v_add_u32 v135, 57600, v134
    ds_write_b32 v132, v139 offset:0
    ds_write_b128 v134, v[136:139] offset:40192
    ds_write_b128 v134, v[136:139] offset:48896
    ds_write_b128 v135, v[136:139] offset:0
    ds_write_b128 v135, v[136:139] offset:8704
    ds_write_b128 v135, v[136:139] offset:17408
    ds_write_b128 v135, v[136:139] offset:26112
    ds_write_b128 v135, v[136:139] offset:34816
    ds_write_b128 v135, v[136:139] offset:43520
    s_mul_i32 s10, s29, 5120
    s_add_u32 s10, s10, 122112
    v_mov_b32 v139, -1
    v_lshl_add_u32 v134, v241, 3, s10
    s_mov_b32 s101, 0
    ds_write_b32 v134, v139 offset:4
    s_mov_b32 s4, s52
    s_mov_b32 s5, s53
    s_mov_b32 s6, 18432
    s_mov_b32 s7, 0x20000
    s_cmp_lt_u32 s28, 4
    s_cselect_b32 s68, s50, s48
    s_cselect_b32 s69, s51, s49
    s_mov_b32 s70, 8192
    s_mov_b32 s71, 0x20000
    s_mov_b32 s12, s40
    s_or_b32 s13, s41, 8388608
    s_mov_b32 s14, 50000
    s_mov_b32 s15, 0x20000
    s_mov_b32 s16, s42
    s_or_b32 s17, s43, 2097152
    s_mov_b32 s18, 800000
    s_mov_b32 s19, 0x20000
    s_mov_b32 s24, s54
    s_mov_b32 s25, s55
    s_mov_b32 s26, 6400000
    s_mov_b32 s27, 0x20000
    s_lshl_b32 s31, s28, 12
    s_add_u32 s31, s31, 40192
    s_lshl_b32 s32, s28, 11
    s_add_u32 s32, s32, 105728
    s_mov_b32 s33, 0
    v_lshlrev_b32 v244, 4, v241
    v_and_b32 v246, 7, v241
    v_lshrrev_b32 v247, 4, v241
    v_xor_b32 v246, v246, v247
    v_lshlrev_b32 v213, 4, v246
    v_xor_b32 v215, 64, v213
    v_mov_b32 v217, v213
    v_mov_b32 v219, v215
    v_and_b32 v246, 1, v246
    v_lshlrev_b32 v221, 4, v246
    v_and_b32 v247, 0x18, v241
    s_sub_u32 s10, s36, 7
    v_lshl_add_u32 v247, v243, 2, v247
    v_add_u32 v212, s10, v247
    v_add_u32 v214, 2, v212
    v_add_u32 v216, 1, v212
    v_add_u32 v218, 3, v212
    s_mov_b32 exec_lo, 0xff
    s_mov_b32 exec_hi, 0xff
    v_mov_b32 v212, 0xffff
    v_mov_b32 v214, 0xffff
    v_mov_b32 v216, 0xffff
    s_mov_b32 exec_hi, 0
    v_mov_b32 v218, 0xffff
    s_mov_b64 exec, -1
    s_sub_u32 s73, s73, s72
    v_cmp_gt_u32 s[40:41], s73, v130
    v_add_u32 v131, 8192, v131
    v_add_u32 v134, 12288, v132
    v_cmp_gt_u32 s[42:43], s73, v131
    v_cmp_gt_u32 s[44:45], s73, v134
    s_mov_b32 s46, 85599
    s_mov_b32 s49, 536870912
    s_mov_b32 s50, 4194304
    s_mov_b32 s51, 40192
    v_mov_b32 v128, -49
    v_mov_b32 v135, 87382
    v_lshlrev_b32 v104, 16, v132
    v_add_u32 v105, 65536, v104
    v_add_u32 v106, 131072, v104
    v_add_u32 v107, 196608, v104
    v_lshlrev_b32 v108, 14, v131
    v_add_u32 v109, 65536, v108
    v_lshlrev_b32 v110, 14, v134
    v_lshrrev_b32 v150, 3, v239
    v_and_b32 v148, 7, v239
    v_lshlrev_b32 v148, 4, v148
    v_lshl_add_u32 v147, v150, 15, v148
    v_mul_u32_u24 v149, 272, v150
    v_lshlrev_b32 v150, 2, v150
    v_add3_u32 v148, v148, v149, s51
    v_add_u32 v149, 34816, v148
    s_waitcnt lgkmcnt(0)
    s_barrier
    s_lshl_b32 s10, s28, 11
    s_add_u32 m0, s10, 5376
    s_nop 0
    buffer_load_dwordx4 v244, s[4:7], s38 offen lds
    s_add_u32 m0, s10, 6400
    s_add_u32 s38, s38, 1024
    buffer_load_dwordx4 v244, s[4:7], s38 offen lds
    s_add_u32 m0, s10, 23808
    s_nop 0
    buffer_load_dwordx4 v244, s[68:71], s39 offen lds
    s_add_u32 m0, s10, 24832
    s_add_u32 s39, s39, 1024
    buffer_load_dwordx4 v244, s[68:71], s39 offen lds
    buffer_load_dwordx4 v[168:171], v[212:213], s[12:15], 0 idxen offen
    buffer_load_dwordx4 v[172:175], v[214:215], s[12:15], 0 idxen offen
    buffer_load_dwordx4 v[176:179], v[216:217], s[12:15], 0 idxen offen
    buffer_load_dwordx4 v[180:183], v[218:219], s[12:15], 0 idxen offen
    s_waitcnt vmcnt(9)
    s_cmp_eq_u32 s28, 7
    s_cbranch_scc0 M_nojc0
    s_mov_b32 s38, 16384
    s_mov_b32 m0, 21760
    s_nop 0
    buffer_load_dwordx4 v244, s[4:7], s38 offen lds
    s_mov_b32 m0, 22784
    s_add_u32 s38, s38, 1024
    buffer_load_dwordx4 v244, s[4:7], s38 offen lds
M_nojc0:
    s_mov_b64 exec, s[40:41]
    v_mul_u32_u24 v112, s46, v88
    v_mul_u32_u24 v113, s46, v89
    v_mul_u32_u24 v114, s46, v90
    v_mul_u32_u24 v115, s46, v91
    v_lshrrev_b32 v112, 22, v112
    v_lshrrev_b32 v113, 22, v113
    v_lshrrev_b32 v114, 22, v114
    v_lshrrev_b32 v115, 22, v115
    v_mad_i32_i24 v88, v112, v128, v88
    v_lshl_add_u32 v104, v112, 30, v104
    v_and_b32 v112, 0x3fc, v112
    ds_add_rtn_u32 v120, v112, v135 offset:0
    v_mul_u32_u24 v112, 68, v112
    v_mad_i32_i24 v89, v113, v128, v89
    v_lshl_add_u32 v105, v113, 30, v105
    v_and_b32 v113, 0x3fc, v113
    ds_add_rtn_u32 v121, v113, v135 offset:0
    v_mul_u32_u24 v113, 68, v113
    v_mad_i32_i24 v90, v114, v128, v90
    v_lshl_add_u32 v106, v114, 30, v106
    v_and_b32 v114, 0x3fc, v114
    ds_add_rtn_u32 v122, v114, v135 offset:0
    v_mul_u32_u24 v114, 68, v114
    v_mad_i32_i24 v91, v115, v128, v91
    v_lshl_add_u32 v107, v115, 30, v107
    v_and_b32 v115, 0x3fc, v115
    ds_add_rtn_u32 v123, v115, v135 offset:0
    v_mul_u32_u24 v115, 68, v115
    v_subrev_u32 v140, 25, v88
    v_and_or_b32 v104, v140, s49, v104
    v_min_u32 v88, v88, v140
    v_or_b32 v104, v104, v96
    v_subrev_u32 v141, 25, v89
    v_and_or_b32 v105, v141, s49, v105
    v_min_u32 v89, v89, v141
    v_or_b32 v105, v105, v97
    v_subrev_u32 v142, 25, v90
    v_and_or_b32 v106, v142, s49, v106
    v_min_u32 v90, v90, v142
    v_or_b32 v106, v106, v98
    v_subrev_u32 v143, 25, v91
    v_and_or_b32 v107, v143, s49, v107
    v_min_u32 v91, v91, v143
    v_or_b32 v107, v107, v99
    s_mov_b64 exec, s[42:43]
    v_mul_u32_u24 v116, s46, v92
    v_mul_u32_u24 v117, s46, v93
    v_lshrrev_b32 v116, 22, v116
    v_lshrrev_b32 v117, 22, v117
    v_mad_i32_i24 v92, v116, v128, v92
    v_lshl_add_u32 v108, v116, 30, v108
    v_and_b32 v116, 0x3fc, v116
    ds_add_rtn_u32 v124, v116, v135 offset:0
    v_mul_u32_u24 v116, 68, v116
    v_mad_i32_i24 v93, v117, v128, v93
    v_lshl_add_u32 v109, v117, 30, v109
    v_and_b32 v117, 0x3fc, v117
    ds_add_rtn_u32 v125, v117, v135 offset:0
    v_mul_u32_u24 v117, 68, v117
    v_subrev_u32 v144, 25, v92
    v_and_or_b32 v108, v144, s49, v108
    v_min_u32 v92, v92, v144
    v_or_b32 v108, v108, v100
    v_subrev_u32 v145, 25, v93
    v_and_or_b32 v109, v145, s49, v109
    v_min_u32 v93, v93, v145
    v_or_b32 v109, v109, v101
    s_mov_b64 exec, s[44:45]
    s_cbranch_execz M_nog3a
    v_mul_u32_u24 v118, s46, v94
    v_lshrrev_b32 v118, 22, v118
    v_mad_i32_i24 v94, v118, v128, v94
    v_lshl_add_u32 v110, v118, 30, v110
    v_and_b32 v118, 0x3fc, v118
    ds_add_rtn_u32 v126, v118, v135 offset:0
    v_mul_u32_u24 v118, 68, v118
    v_subrev_u32 v146, 25, v94
    v_and_or_b32 v110, v146, s49, v110
    v_min_u32 v94, v94, v146
    v_or_b32 v110, v110, v102
    s_waitcnt lgkmcnt(0)
    v_min_u32 v126, s50, v126
    v_mad_u32_u16 v118, v126, 4, v118 op_sel:[1,0,0,0]
    v_bfe_u32 v126, v126, 16, 2
    ds_write_b32 v118, v110 offset:40192
    v_mad_i32_i24 v118, v126, -3, v118
    ds_write_b8 v118, v94 offset:40204
M_nog3a:
    s_waitcnt lgkmcnt(2)
    s_mov_b64 exec, s[40:41]
    v_min_u32 v120, s50, v120
    v_mad_u32_u16 v112, v120, 4, v112 op_sel:[1,0,0,0]
    v_bfe_u32 v120, v120, 16, 2
    ds_write_b32 v112, v104 offset:40192
    v_mad_i32_i24 v112, v120, -3, v112
    ds_write_b8 v112, v88 offset:40204
    v_min_u32 v121, s50, v121
    v_mad_u32_u16 v113, v121, 4, v113 op_sel:[1,0,0,0]
    v_bfe_u32 v121, v121, 16, 2
    ds_write_b32 v113, v105 offset:40192
    v_mad_i32_i24 v113, v121, -3, v113
    ds_write_b8 v113, v89 offset:40204
    v_min_u32 v122, s50, v122
    v_mad_u32_u16 v114, v122, 4, v114 op_sel:[1,0,0,0]
    v_bfe_u32 v122, v122, 16, 2
    ds_write_b32 v114, v106 offset:40192
    v_mad_i32_i24 v114, v122, -3, v114
    ds_write_b8 v114, v90 offset:40204
    v_min_u32 v123, s50, v123
    v_mad_u32_u16 v115, v123, 4, v115 op_sel:[1,0,0,0]
    v_bfe_u32 v123, v123, 16, 2
    ds_write_b32 v115, v107 offset:40192
    v_mad_i32_i24 v115, v123, -3, v115
    ds_write_b8 v115, v91 offset:40204
    s_mov_b64 exec, s[42:43]
    s_waitcnt lgkmcnt(8)
    v_min_u32 v124, s50, v124
    v_mad_u32_u16 v116, v124, 4, v116 op_sel:[1,0,0,0]
    v_bfe_u32 v124, v124, 16, 2
    ds_write_b32 v116, v108 offset:40192
    v_mad_i32_i24 v116, v124, -3, v116
    ds_write_b8 v116, v92 offset:40204
    v_min_u32 v125, s50, v125
    v_mad_u32_u16 v117, v125, 4, v117 op_sel:[1,0,0,0]
    v_bfe_u32 v125, v125, 16, 2
    ds_write_b32 v117, v109 offset:40192
    v_mad_i32_i24 v117, v125, -3, v117
    ds_write_b8 v117, v93 offset:40204
    s_mov_b64 exec, -1
    s_waitcnt vmcnt(8)
    v_readfirstlane_b32 s72, v238
    s_lshl_b32 s74, s34, 7
    s_add_u32 s74, s74, 1048576
    s_mov_b32 s73, 4292927712
    s_orn2_b32 s72, s72, s73
    s_add_u32 s72, s72, 1
    s_and_b32 s72, s72, s73
    s_mov_b32 s51, 2162688
    s_waitcnt lgkmcnt(0)
    s_barrier
    ds_read2st64_b32 v[120:121], v150 offset0:0 offset1:1
    ds_read2st64_b32 v[122:123], v150 offset0:2 offset1:3
    ds_read_b128 v[88:91], v148 offset:0
    ds_read_b128 v[92:95], v148 offset:17408
    ds_read_b128 v[96:99], v149 offset:0
    ds_read_b128 v[100:103], v149 offset:17408
    s_waitcnt lgkmcnt(4)
    v_max_u32 v124, v120, v121
    v_max3_u32 v124, v124, v122, v123
    v_cmp_le_u32 vcc, s51, v124
    s_cbranch_vccnz M_flag
M_flagged:
    s_add_u32 s75, s74, 0
    s_waitcnt lgkmcnt(3)
    v_xor_b32 v91, s72, v91
    buffer_store_dwordx4 v[88:91], v147, s[20:23], s75 offen sc1
    s_add_u32 s75, s74, 2097152
    s_waitcnt lgkmcnt(2)
    v_xor_b32 v95, s72, v95
    buffer_store_dwordx4 v[92:95], v147, s[20:23], s75 offen sc1
    s_add_u32 s75, s74, 4194304
    s_waitcnt lgkmcnt(1)
    v_xor_b32 v99, s72, v99
    buffer_store_dwordx4 v[96:99], v147, s[20:23], s75 offen sc1
    s_add_u32 s75, s74, 6291456
    s_waitcnt lgkmcnt(0)
    v_xor_b32 v103, s72, v103
    buffer_store_dwordx4 v[100:103], v147, s[20:23], s75 offen sc1
    s_cbranch_vccz M_no2
    s_mov_b64 exec, vcc
    ds_read_b128 v[104:107], v148 offset:128
    ds_read_b128 v[108:111], v148 offset:17536
    ds_read_b128 v[112:115], v149 offset:128
    ds_read_b128 v[116:119], v149 offset:17536
    s_waitcnt lgkmcnt(0)
    v_or_b32 v107, s72, v107
    s_add_u32 s75, s74, 8388608
    buffer_store_dwordx4 v[104:107], v147, s[20:23], s75 offen sc1
    v_or_b32 v111, s72, v111
    s_add_u32 s75, s74, 10485760
    buffer_store_dwordx4 v[108:111], v147, s[20:23], s75 offen sc1
    v_or_b32 v115, s72, v115
    s_add_u32 s75, s74, 12582912
    buffer_store_dwordx4 v[112:115], v147, s[20:23], s75 offen sc1
    v_or_b32 v119, s72, v119
    s_add_u32 s75, s74, 14680064
    buffer_store_dwordx4 v[116:119], v147, s[20:23], s75 offen sc1
    s_mov_b64 exec, -1
    s_waitcnt vmcnt(8)
    s_branch M_no2b
M_no2:
    s_waitcnt vmcnt(4)
M_no2b:
    s_mov_b32 s4, s56
    s_mov_b32 s5, s57
    s_mov_b32 s6, 256
    s_mov_b32 s7, 0x20000
    s_lshl_b32 s64, s3, 15
    s_lshl_b32 s10, s28, 12
    s_add_u32 s64, s64, s10
    s_add_u32 s64, s64, 1048576
    s_add_u32 s65, s64, 1024
    s_add_u32 s66, s64, 2048
    s_add_u32 s67, s64, 3072
    v_lshlrev_b32 v57, 2, v242
    v_lshl_add_u32 v57, v243, 10, v57
    s_lshl_b32 s10, s28, 11
    s_add_u32 s10, s10, 5376
    v_add_u32 v58, s10, v57
    v_add_u32 v56, s10, v244
    ds_read_b32 v0, v58 offset:0
    ds_read_b32 v1, v58 offset:128
    ds_read_b32 v2, v58 offset:256
    ds_read_b32 v3, v58 offset:384
    ds_read_b32 v4, v58 offset:512
    ds_read_b32 v5, v58 offset:640
    ds_read_b32 v6, v58 offset:768
    ds_read_b32 v7, v58 offset:896
    v_lshrrev_b32 v246, 1, v242
    v_and_b32 v246, 7, v246
    v_xor_b32 v246, v246, v243
    v_lshlrev_b32 v247, 7, v242
    v_add_u32 v247, s31, v247
    v_xor_b32 v229, 0, v246
    v_lshl_add_u32 v229, v229, 4, v247
    v_xor_b32 v230, 2, v246
    v_lshl_add_u32 v230, v230, 4, v247
    v_xor_b32 v231, 4, v246
    v_lshl_add_u32 v231, v231, 4, v247
    v_xor_b32 v232, 6, v246
    v_lshl_add_u32 v232, v232, 4, v247
    v_lshrrev_b32 v246, 3, v242
    v_and_b32 v246, 1, v246
    v_xor_b32 v246, v246, v243
    v_lshlrev_b32 v247, 5, v242
    v_add_u32 v247, s32, v247
    v_lshl_add_u32 v233, v246, 4, v247
    v_mov_b32 v223, 0x3f80
    v_lshlrev_b32 v223, v245, v223
    v_and_b32 v246, 16, v241
    v_lshlrev_b32 v246, 1, v246
    v_and_b32 v247, 3, v241
    v_lshl_add_u32 v246, v247, 3, v246
    v_add_u32 v228, 2560, v246
    v_add_u32 v245, 5376, v244
    s_cmp_lt_u32 s28, 4
    s_cselect_b32 s10, 1.0, 3216550459
    s_waitcnt lgkmcnt(0)
    ds_read_b32 v8, v58 offset:18432
    ds_read_b32 v9, v58 offset:18560
    ds_read_b32 v10, v58 offset:18688
    ds_read_b32 v11, v58 offset:18816
    ds_read_b32 v12, v58 offset:18944
    ds_read_b32 v13, v58 offset:19072
    ds_read_b32 v14, v58 offset:19200
    ds_read_b32 v15, v58 offset:19328
    v_lshlrev_b32 v24, 16, v0
    v_and_b32 v0, 0xffff0000, v0
    v_lshlrev_b32 v25, 16, v1
    v_and_b32 v1, 0xffff0000, v1
    v_lshlrev_b32 v26, 16, v2
    v_and_b32 v2, 0xffff0000, v2
    v_lshlrev_b32 v27, 16, v3
    v_and_b32 v3, 0xffff0000, v3
    v_lshlrev_b32 v28, 16, v4
    v_and_b32 v4, 0xffff0000, v4
    v_lshlrev_b32 v29, 16, v5
    v_and_b32 v5, 0xffff0000, v5
    v_lshlrev_b32 v30, 16, v6
    v_and_b32 v6, 0xffff0000, v6
    v_lshlrev_b32 v31, 16, v7
    v_and_b32 v7, 0xffff0000, v7
    v_mul_f32 v24, s10, v24
    v_mul_f32 v0, s10, v0
    v_mul_f32 v25, s10, v25
    v_mul_f32 v1, s10, v1
    v_mul_f32 v26, s10, v26
    v_mul_f32 v2, s10, v2
    v_mul_f32 v27, s10, v27
    v_mul_f32 v3, s10, v3
    v_mul_f32 v28, s10, v28
    v_mul_f32 v4, s10, v4
    v_mul_f32 v29, s10, v29
    v_mul_f32 v5, s10, v5
    v_mul_f32 v30, s10, v30
    v_mul_f32 v6, s10, v6
    v_mul_f32 v31, s10, v31
    v_mul_f32 v7, s10, v7
    v_cvt_pk_bf16_f32 v32, v24, v25
    v_cvt_pk_bf16_f32 v36, v0, v1
    v_cvt_pk_bf16_f32 v33, v26, v27
    v_cvt_pk_bf16_f32 v37, v2, v3
    v_cvt_pk_bf16_f32 v34, v28, v29
    v_cvt_pk_bf16_f32 v38, v4, v5
    v_cvt_pk_bf16_f32 v35, v30, v31
    v_cvt_pk_bf16_f32 v39, v6, v7
    ds_write_b128 v56, v[32:35] offset:0
    ds_write_b128 v56, v[36:39] offset:1024
    s_mov_b32 s10, 0x05040100
    s_mov_b32 s11, 0x07060302
    s_waitcnt lgkmcnt(2)
    v_perm_b32 v40, v9, v8, s10
    v_perm_b32 v44, v9, v8, s11
    v_perm_b32 v41, v11, v10, s10
    v_perm_b32 v45, v11, v10, s11
    v_perm_b32 v42, v13, v12, s10
    v_perm_b32 v46, v13, v12, s11
    v_perm_b32 v43, v15, v14, s10
    v_perm_b32 v47, v15, v14, s11
    ds_write_b128 v56, v[40:43] offset:18432
    ds_write_b128 v56, v[44:47] offset:19456
    s_cmp_eq_u32 s28, 7
    s_cbranch_scc0 M_nojc
    ds_read_b32 v16, v57 offset:21760
    ds_read_b32 v17, v57 offset:21888
    ds_read_b32 v18, v57 offset:22016
    ds_read_b32 v19, v57 offset:22144
    ds_read_b32 v20, v57 offset:22272
    ds_read_b32 v21, v57 offset:22400
    ds_read_b32 v22, v57 offset:22528
    ds_read_b32 v23, v57 offset:22656
    s_mov_b32 s10, 3216550459
    s_waitcnt lgkmcnt(0)
    v_lshlrev_b32 v24, 16, v16
    v_and_b32 v16, 0xffff0000, v16
    v_lshlrev_b32 v25, 16, v17
    v_and_b32 v17, 0xffff0000, v17
    v_lshlrev_b32 v26, 16, v18
    v_and_b32 v18, 0xffff0000, v18
    v_lshlrev_b32 v27, 16, v19
    v_and_b32 v19, 0xffff0000, v19
    v_lshlrev_b32 v28, 16, v20
    v_and_b32 v20, 0xffff0000, v20
    v_lshlrev_b32 v29, 16, v21
    v_and_b32 v21, 0xffff0000, v21
    v_lshlrev_b32 v30, 16, v22
    v_and_b32 v22, 0xffff0000, v22
    v_lshlrev_b32 v31, 16, v23
    v_and_b32 v23, 0xffff0000, v23
    v_mul_f32 v24, s10, v24
    v_mul_f32 v16, s10, v16
    v_mul_f32 v25, s10, v25
    v_mul_f32 v17, s10, v17
    v_mul_f32 v26, s10, v26
    v_mul_f32 v18, s10, v18
    v_mul_f32 v27, s10, v27
    v_mul_f32 v19, s10, v19
    v_mul_f32 v28, s10, v28
    v_mul_f32 v20, s10, v20
    v_mul_f32 v29, s10, v29
    v_mul_f32 v21, s10, v21
    v_mul_f32 v30, s10, v30
    v_mul_f32 v22, s10, v22
    v_mul_f32 v31, s10, v31
    v_mul_f32 v23, s10, v23
    v_cvt_pk_bf16_f32 v32, v24, v25
    v_cvt_pk_bf16_f32 v36, v16, v17
    v_cvt_pk_bf16_f32 v33, v26, v27
    v_cvt_pk_bf16_f32 v37, v18, v19
    v_cvt_pk_bf16_f32 v34, v28, v29
    v_cvt_pk_bf16_f32 v38, v20, v21
    v_cvt_pk_bf16_f32 v35, v30, v31
    v_cvt_pk_bf16_f32 v39, v22, v23
    ds_write_b128 v245, v[32:35] offset:16384
    ds_write_b128 v245, v[36:39] offset:17408
M_nojc:
    s_cmp_eq_u32 s28, 6
    s_cbranch_scc0 M_nocnt
    v_and_b32 v140, 63, v239
    v_lshrrev_b32 v141, 1, v140
    v_and_b32 v142, 3, v140
    v_and_or_b32 v141, v141, 28, v142
    v_and_b32 v142, 4, v140
    v_mul_u32_u24 v141, 1280, v141
    v_cmp_eq_u32 vcc, 0, v142
    v_add_u32 v141, 122112, v141
    v_lshlrev_b32 v140, 2, v140
    v_cndmask_b32 v141, 0, v141, vcc
    ds_write_b32 v140, v141 offset:5120
M_nocnt:
    v_add_u32 v60, s31, v244
    s_mov_b32 s39, 3758102528
    s_mov_b32 s35, 0
    s_waitcnt lgkmcnt(0)
    s_barrier
    ds_write_b128 v60, v[168:171] offset:0
    ds_write_b128 v60, v[172:175] offset:1024
    ds_write_b128 v60, v[176:179] offset:2048
    ds_write_b128 v60, v[180:183] offset:3072
    s_cmp_eq_u32 s28, 3
    s_cbranch_scc0 M_notab
    v_mov_b32 v140, 0
    v_mov_b32 v141, 0
    v_mov_b32 v142, 0
    v_mov_b32 v143, 0
    ds_write_b128 v244, v[140:143] offset:2048
    ds_write_b128 v244, v[140:143] offset:3072
    ds_write_b128 v244, v[140:143] offset:4096
    v_bfrev_b32 v144, v242
    v_lshrrev_b32 v145, 3, v242
    v_lshrrev_b32 v144, 27, v144
    v_mul_u32_u24 v146, 80, v242
    v_and_or_b32 v144, v144, 28, v145
    v_mov_b32 v147, 0x3f80
    v_lshl_add_u32 v146, v144, 1, v146
    s_mov_b32 exec_lo, 0xffffff80
    s_mov_b32 exec_hi, 0
    ds_write_b16 v146, v147 offset:2560
    s_mov_b64 exec, -1
M_notab:
    s_branch M_pq0
.p2align 12
M_pp0:
    s_branch M_pback
M_pq0:
    v_lshrrev_b32 v246, 3, v241
    s_lshl_b32 s10, s28, 5
    v_add_u32 v246, s10, v246
    v_mul_u32_u24 v246, 3128, v246
    v_mov_b32 v243, 8
    s_waitcnt lgkmcnt(0)
    ds_read_b128 v[168:171], v229 offset:0
    ds_read_b128 v[172:175], v230 offset:0
    ds_read_b128 v[176:179], v231 offset:0
    ds_read_b128 v[180:183], v232 offset:0
    ds_read_b128 v[0:3], v245 offset:0
    ds_read_b128 v[4:7], v245 offset:1024
    ds_read_b128 v[8:11], v245 offset:2048
    ds_read_b128 v[12:15], v245 offset:3072
    ds_read_b128 v[16:19], v245 offset:4096
    ds_read_b128 v[20:23], v245 offset:5120
    ds_read_b128 v[24:27], v245 offset:6144
    ds_read_b128 v[28:31], v245 offset:7168
    s_waitcnt lgkmcnt(7)
    v_mfma_f32_32x32x16_bf16 v[120:135], v[168:171], v[0:3], 0
    ds_read_b128 v[32:35], v245 offset:26624
    s_waitcnt lgkmcnt(7)
    v_mfma_f32_32x32x16_bf16 v[136:151], v[168:171], v[4:7], 0
    ds_read_b128 v[36:39], v245 offset:27648
    s_waitcnt lgkmcnt(7)
    v_mfma_f32_32x32x16_bf16 v[120:135], v[172:175], v[8:11], v[120:135]
    ds_read_b128 v[40:43], v245 offset:28672
    s_waitcnt lgkmcnt(7)
    v_mfma_f32_32x32x16_bf16 v[136:151], v[172:175], v[12:15], v[136:151]
    ds_read_b128 v[44:47], v245 offset:29696
    s_waitcnt lgkmcnt(7)
    v_mfma_f32_32x32x16_bf16 v[120:135], v[176:179], v[16:19], v[120:135]
    ds_read_b128 v[48:51], v245 offset:30720
    s_waitcnt lgkmcnt(7)
    v_mfma_f32_32x32x16_bf16 v[136:151], v[176:179], v[20:23], v[136:151]
    ds_read_b128 v[52:55], v245 offset:31744
    s_waitcnt lgkmcnt(7)
    v_mfma_f32_32x32x16_bf16 v[120:135], v[180:183], v[24:27], v[120:135]
    ds_read_b128 v[56:59], v245 offset:32768
    s_waitcnt lgkmcnt(7)
    v_mfma_f32_32x32x16_bf16 v[136:151], v[180:183], v[28:31], v[136:151]
    ds_read_b128 v[60:63], v245 offset:33792
    buffer_load_dwordx4 v[152:155], v244, s[20:23], s64 offen sc1
    buffer_load_dwordx4 v[156:159], v244, s[20:23], s65 offen sc1
    buffer_load_dwordx4 v[160:163], v244, s[20:23], s66 offen sc1
    buffer_load_dwordx4 v[164:167], v244, s[20:23], s67 offen sc1
    s_nop 7
    s_nop 7
    s_mov_b32 s10, 3216550459
    v_mul_f32 v132, s10, v132
    v_mul_f32 v148, s10, v148
    v_mov_b32 v72, 0
    v_cvt_pk_bf16_f32 v73, v132, v132
    v_mov_b32 v76, 0
    v_cvt_pk_bf16_f32 v77, v148, v148
    v_lshlrev_b32 v73, 16, v73
    v_mov_b32 v74, v73
    v_lshlrev_b32 v77, 16, v77
    v_mov_b32 v78, v77
    s_nop 1
    v_permlane32_swap_b32 v74, v72
    v_permlane32_swap_b32 v78, v76
    s_nop 1
    v_add_f32 v73, v72, v73
    v_add_f32 v77, v76, v77
    v_fma_f32 v121, v121, s10, -v73
    v_fma_f32 v122, v122, s10, -v73
    v_fma_f32 v123, v123, s10, -v73
    v_fma_f32 v125, v125, s10, -v73
    v_fma_f32 v126, v126, s10, -v73
    v_fma_f32 v127, v127, s10, -v73
    v_fma_f32 v129, v129, s10, -v73
    v_fma_f32 v130, v130, s10, -v73
    v_fma_f32 v131, v131, s10, -v73
    v_fma_f32 v133, v133, s10, -v72
    v_fma_f32 v134, v134, s10, -v72
    v_fma_f32 v135, v135, s10, -v72
    v_fma_f32 v137, v137, s10, -v77
    v_fma_f32 v138, v138, s10, -v77
    v_fma_f32 v139, v139, s10, -v77
    v_fma_f32 v141, v141, s10, -v77
    v_fma_f32 v142, v142, s10, -v77
    v_fma_f32 v143, v143, s10, -v77
    v_fma_f32 v145, v145, s10, -v77
    v_fma_f32 v146, v146, s10, -v77
    v_fma_f32 v147, v147, s10, -v77
    v_fma_f32 v149, v149, s10, -v76
    v_fma_f32 v150, v150, s10, -v76
    v_fma_f32 v151, v151, s10, -v76
    v_cvt_pk_bf16_f32 v72, v120, v121
    v_cvt_pk_bf16_f32 v73, v122, v123
    v_cvt_pk_bf16_f32 v74, v124, v125
    v_cvt_pk_bf16_f32 v75, v126, v127
    v_cvt_pk_bf16_f32 v76, v128, v129
    v_cvt_pk_bf16_f32 v77, v130, v131
    v_cvt_pk_bf16_f32 v78, v132, v133
    v_cvt_pk_bf16_f32 v79, v134, v135
    v_cvt_pk_bf16_f32 v80, v136, v137
    v_cvt_pk_bf16_f32 v81, v138, v139
    v_cvt_pk_bf16_f32 v82, v140, v141
    v_cvt_pk_bf16_f32 v83, v142, v143
    v_cvt_pk_bf16_f32 v84, v144, v145
    v_cvt_pk_bf16_f32 v85, v146, v147
    v_cvt_pk_bf16_f32 v86, v148, v149
    v_cvt_pk_bf16_f32 v87, v150, v151
    s_waitcnt lgkmcnt(0)
    s_mov_b32 s96, 201850880
    s_mov_b32 s97, 201851908
    v_add_u32 v88, 0, v246
    v_add_u32 v89, 25024, v246
    v_add_u32 v90, 50048, v246
    v_add_u32 v91, 75072, v246
    v_mov_b32 v92, 67240192
    v_mov_b32 v93, 84017408
    v_mov_b32 v94, 100794624
    v_mov_b32 v95, 0x0e0e0e
    s_mul_i32 s10, s29, 5120
    s_add_u32 s10, s10, 122112
    v_and_b32 v234, 0x38, v241
    v_lshrrev_b32 v235, 1, v241
    v_add_u32 v234, s10, v234
    v_lshl_add_u32 v235, v235, 3, s10
M_poll:
    s_waitcnt vmcnt(0)
M_poll1:
    v_xor_b32 v96, s72, v155
    v_xor_b32 v97, s72, v159
    v_xor_b32 v98, s72, v163
    v_xor_b32 v99, s72, v167
    v_or3_b32 v100, v96, v97, v98
    v_or_b32 v100, v100, v99
    v_and_b32 v100, s73, v100
    v_cmp_ne_u32 vcc, 0, v100
    s_cbranch_vccnz M_repoll
M_route:
    v_lshl_add_u32 v96, v96, 1, v95
    v_and_b32 v136, s39, v152
    v_cmpx_ne_u16 s[48:49], -1, v152
    v_lshrrev_b32_sdwa v184, v136, s96 dst_sel:DWORD dst_unused:UNUSED_PAD src0_sel:BYTE_1 src1_sel:DWORD
    v_or_b32_sdwa v136, v136, v184 dst_sel:DWORD dst_unused:UNUSED_PAD src0_sel:BYTE_3 src1_sel:BYTE_0
    v_perm_b32 v184, v96, v88, v92
    ds_add_rtn_u32 v136, v136, v243 offset:5120
    v_and_b32 v137, s39, v153
    v_cmpx_ne_u16 s[50:51], -1, v153
    v_lshrrev_b32_sdwa v185, v137, s96 dst_sel:DWORD dst_unused:UNUSED_PAD src0_sel:BYTE_1 src1_sel:DWORD
    v_or_b32_sdwa v137, v137, v185 dst_sel:DWORD dst_unused:UNUSED_PAD src0_sel:BYTE_3 src1_sel:BYTE_0
    v_perm_b32 v185, v96, v88, v93
    ds_add_rtn_u32 v137, v137, v243 offset:5120
    v_and_b32 v138, s39, v154
    v_cmpx_ne_u16 s[52:53], -1, v154
    v_lshrrev_b32_sdwa v186, v138, s96 dst_sel:DWORD dst_unused:UNUSED_PAD src0_sel:BYTE_1 src1_sel:DWORD
    v_or_b32_sdwa v138, v138, v186 dst_sel:DWORD dst_unused:UNUSED_PAD src0_sel:BYTE_3 src1_sel:BYTE_0
    v_perm_b32 v186, v96, v88, v94
    ds_add_rtn_u32 v138, v138, v243 offset:5120
    s_mov_b64 exec, -1
    v_lshl_add_u32 v97, v97, 1, v95
    v_and_b32 v139, s39, v156
    v_cmpx_ne_u16 s[54:55], -1, v156
    v_lshrrev_b32_sdwa v187, v139, s96 dst_sel:DWORD dst_unused:UNUSED_PAD src0_sel:BYTE_1 src1_sel:DWORD
    v_or_b32_sdwa v139, v139, v187 dst_sel:DWORD dst_unused:UNUSED_PAD src0_sel:BYTE_3 src1_sel:BYTE_0
    v_perm_b32 v187, v97, v89, v92
    ds_add_rtn_u32 v139, v139, v243 offset:5120
    v_and_b32 v140, s39, v157
    v_cmpx_ne_u16 s[56:57], -1, v157
    v_lshrrev_b32_sdwa v188, v140, s96 dst_sel:DWORD dst_unused:UNUSED_PAD src0_sel:BYTE_1 src1_sel:DWORD
    v_or_b32_sdwa v140, v140, v188 dst_sel:DWORD dst_unused:UNUSED_PAD src0_sel:BYTE_3 src1_sel:BYTE_0
    v_perm_b32 v188, v97, v89, v93
    ds_add_rtn_u32 v140, v140, v243 offset:5120
    v_and_b32 v141, s39, v158
    v_cmpx_ne_u16 s[58:59], -1, v158
    v_lshrrev_b32_sdwa v189, v141, s96 dst_sel:DWORD dst_unused:UNUSED_PAD src0_sel:BYTE_1 src1_sel:DWORD
    v_or_b32_sdwa v141, v141, v189 dst_sel:DWORD dst_unused:UNUSED_PAD src0_sel:BYTE_3 src1_sel:BYTE_0
    v_perm_b32 v189, v97, v89, v94
    ds_add_rtn_u32 v141, v141, v243 offset:5120
    s_mov_b64 exec, -1
    v_lshl_add_u32 v98, v98, 1, v95
    v_and_b32 v142, s39, v160
    v_cmpx_ne_u16 s[60:61], -1, v160
    v_lshrrev_b32_sdwa v190, v142, s97 dst_sel:DWORD dst_unused:UNUSED_PAD src0_sel:BYTE_1 src1_sel:DWORD
    v_or_b32_sdwa v142, v142, v190 dst_sel:DWORD dst_unused:UNUSED_PAD src0_sel:BYTE_3 src1_sel:BYTE_0
    v_perm_b32 v190, v98, v90, v92
    ds_add_rtn_u32 v142, v142, v243 offset:5120
    v_and_b32 v143, s39, v161
    v_cmpx_ne_u16 s[62:63], -1, v161
    v_lshrrev_b32_sdwa v191, v143, s97 dst_sel:DWORD dst_unused:UNUSED_PAD src0_sel:BYTE_1 src1_sel:DWORD
    v_or_b32_sdwa v143, v143, v191 dst_sel:DWORD dst_unused:UNUSED_PAD src0_sel:BYTE_3 src1_sel:BYTE_0
    v_perm_b32 v191, v98, v90, v93
    ds_add_rtn_u32 v143, v143, v243 offset:5120
    v_and_b32 v144, s39, v162
    v_cmpx_ne_u16 s[68:69], -1, v162
    v_lshrrev_b32_sdwa v192, v144, s97 dst_sel:DWORD dst_unused:UNUSED_PAD src0_sel:BYTE_1 src1_sel:DWORD
    v_or_b32_sdwa v144, v144, v192 dst_sel:DWORD dst_unused:UNUSED_PAD src0_sel:BYTE_3 src1_sel:BYTE_0
    v_perm_b32 v192, v98, v90, v94
    ds_add_rtn_u32 v144, v144, v243 offset:5120
    s_mov_b64 exec, -1
    v_lshl_add_u32 v99, v99, 1, v95
    v_and_b32 v145, s39, v164
    v_cmpx_ne_u16 s[70:71], -1, v164
    v_lshrrev_b32_sdwa v193, v145, s97 dst_sel:DWORD dst_unused:UNUSED_PAD src0_sel:BYTE_1 src1_sel:DWORD
    v_or_b32_sdwa v145, v145, v193 dst_sel:DWORD dst_unused:UNUSED_PAD src0_sel:BYTE_3 src1_sel:BYTE_0
    v_perm_b32 v193, v99, v91, v92
    ds_add_rtn_u32 v145, v145, v243 offset:5120
    v_and_b32 v146, s39, v165
    v_cmpx_ne_u16 s[8:9], -1, v165
    v_lshrrev_b32_sdwa v194, v146, s97 dst_sel:DWORD dst_unused:UNUSED_PAD src0_sel:BYTE_1 src1_sel:DWORD
    v_or_b32_sdwa v146, v146, v194 dst_sel:DWORD dst_unused:UNUSED_PAD src0_sel:BYTE_3 src1_sel:BYTE_0
    v_perm_b32 v194, v99, v91, v93
    ds_add_rtn_u32 v146, v146, v243 offset:5120
    v_and_b32 v147, s39, v166
    v_cmpx_ne_u16 s[74:75], -1, v166
    v_lshrrev_b32_sdwa v195, v147, s97 dst_sel:DWORD dst_unused:UNUSED_PAD src0_sel:BYTE_1 src1_sel:DWORD
    v_or_b32_sdwa v147, v147, v195 dst_sel:DWORD dst_unused:UNUSED_PAD src0_sel:BYTE_3 src1_sel:BYTE_0
    v_perm_b32 v195, v99, v91, v94
    ds_add_rtn_u32 v147, v147, v243 offset:5120
    s_mov_b64 exec, s[48:49]
    s_waitcnt lgkmcnt(0)
    ds_write2_b32 v136, v152, v184 offset1:1
    s_mov_b64 exec, s[50:51]
    ds_write2_b32 v137, v153, v185 offset1:1
    s_mov_b64 exec, s[52:53]
    ds_write2_b32 v138, v154, v186 offset1:1
    s_mov_b64 exec, s[54:55]
    ds_write2_b32 v139, v156, v187 offset1:1
    s_mov_b64 exec, s[56:57]
    ds_write2_b32 v140, v157, v188 offset1:1
    s_mov_b64 exec, s[58:59]
    ds_write2_b32 v141, v158, v189 offset1:1
    s_mov_b64 exec, s[60:61]
    ds_write2_b32 v142, v160, v190 offset1:1
    s_mov_b64 exec, s[62:63]
    ds_write2_b32 v143, v161, v191 offset1:1
    s_mov_b64 exec, s[68:69]
    ds_write2_b32 v144, v162, v192 offset1:1
    s_mov_b64 exec, s[70:71]
    ds_write2_b32 v145, v164, v193 offset1:1
    s_mov_b64 exec, s[8:9]
    ds_write2_b32 v146, v165, v194 offset1:1
    s_mov_b64 exec, s[74:75]
    ds_write2_b32 v147, v166, v195 offset1:1
    s_cmp_lt_u32 s64, 9437184
    s_cbranch_scc0 M_second
M_routed:
    s_mov_b64 exec, 1
    v_mov_b32 v120, 0
    ds_add_u32 v120, v243 offset:1024
    s_mov_b64 exec, -1
    s_movk_i32 s10, 6
    s_cmp_eq_u32 s101, 0
    s_cbranch_scc0 M_ea2
M_ea1:
    s_sub_u32 s10, s10, 1
    s_cbranch_scc1 M_ea2
    s_waitcnt lgkmcnt(0)
    ds_read_b64 v[246:247], v235 offset:0
    ds_read_u16 v212, v234 offset:0
    ds_read_u16 v214, v234 offset:64
    ds_read_u16 v216, v234 offset:128
    ds_read_u16 v218, v234 offset:192
    s_waitcnt lgkmcnt(4)
    v_cmp_eq_u32 vcc, -1, v247
    v_bfe_u32 v220, v246, 16, 12
    v_mad_u32_u24 v220, v247, 1, v220
    s_cbranch_vccnz M_ea1
    s_add_u32 m0, s32, 0
    s_nop 0
    buffer_load_dwordx4 v[220:221], s[16:19], 0 idxen offen  lds
    s_add_u32 m0, s31, 0
    s_waitcnt lgkmcnt(3)
    s_nop 0
    buffer_load_dwordx4 v[212:213], s[12:15], 0 idxen offen lds
    s_add_u32 m0, s31, 1024
    s_waitcnt lgkmcnt(2)
    s_nop 0
    buffer_load_dwordx4 v[214:215], s[12:15], 0 idxen offen lds
    s_add_u32 m0, s31, 2048
    s_waitcnt lgkmcnt(1)
    s_nop 0
    buffer_load_dwordx4 v[216:217], s[12:15], 0 idxen offen lds
    s_add_u32 m0, s31, 3072
    s_waitcnt lgkmcnt(0)
    s_nop 0
    buffer_load_dwordx4 v[218:219], s[12:15], 0 idxen offen lds
    s_mov_b32 s101, 1
M_ea2:
    s_mov_b32 s8, 1065308039
    s_add_u32 s10, s28, 254
    v_mov_b32 v238, s10
    s_mov_b32 s38, s72
    s_waitcnt lgkmcnt(0)
    v_mfma_f32_32x32x16_bf16 v[88:103], v[168:171], v[32:35], 0
    ds_read_b128 v[0:3], v245 offset:8192
    v_mfma_f32_32x32x16_bf16 v[104:119], v[168:171], v[36:39], 0
    ds_read_b128 v[4:7], v245 offset:9216
    v_mfma_f32_32x32x16_bf16 v[88:103], v[172:175], v[40:43], v[88:103]
    ds_read_b128 v[8:11], v245 offset:10240
    v_mfma_f32_32x32x16_bf16 v[104:119], v[172:175], v[44:47], v[104:119]
    ds_read_b128 v[12:15], v245 offset:11264
    v_mfma_f32_32x32x16_bf16 v[88:103], v[176:179], v[48:51], v[88:103]
    ds_read_b128 v[16:19], v245 offset:12288
    v_mfma_f32_32x32x16_bf16 v[104:119], v[176:179], v[52:55], v[104:119]
    ds_read_b128 v[20:23], v245 offset:13312
    v_mfma_f32_32x32x16_bf16 v[88:103], v[180:183], v[56:59], v[88:103]
    ds_read_b128 v[24:27], v245 offset:14336
    v_mfma_f32_32x32x16_bf16 v[104:119], v[180:183], v[60:63], v[104:119]
    ds_read_b128 v[28:31], v245 offset:15360
    ds_read_b128 v[64:67], v245 offset:16384
    ds_read_b128 v[68:71], v245 offset:17408
    s_waitcnt lgkmcnt(2)
    ds_read_b128 v[32:35], v245 offset:18432
    ds_read_b128 v[36:39], v245 offset:19456
    ds_read_b128 v[40:43], v245 offset:20480
    ds_read_b128 v[44:47], v245 offset:21504
    ds_read_b128 v[48:51], v245 offset:22528
    ds_read_b128 v[52:55], v245 offset:23552
    ds_read_b128 v[56:59], v245 offset:24576
    ds_read_b128 v[60:63], v245 offset:25600
M_entry:
    v_and_b32 v120, 7, v239
    v_lshlrev_b32 v121, 5, v120
    s_lshl_b32 s10, s29, 5
    v_mov_b32 v131, s10
    ds_read_b32 v130, v121 offset:1024
    ds_read_b128 v[132:135], v121 offset:5120
    ds_read_b128 v[164:167], v131 offset:5120
    ds_read_b32 v129, v121 offset:5136
    v_and_b32 v241, 63, v239
    v_and_b32 v234, 0x38, v241
    v_lshrrev_b32 v235, 1, v241
    v_lshlrev_b32 v235, 3, v235
    v_and_b32 v236, 31, v241
    v_lshlrev_b32 v236, 3, v236
    v_and_b32 v237, 12, v241
    v_lshlrev_b32 v237, 1, v237
    v_and_b32 v124, 32, v241
    v_lshlrev_b32 v124, 1, v124
    v_mov_b32 v204, 0xdddd
    v_mov_b32 v126, 65535
    s_mov_b32 s75, 40
    v_mov_b32 v127, 0x100000
    v_lshlrev_b32 v125, 3, v241
    s_mul_i32 s37, s29, 5120
    s_add_u32 s37, s37, 122112
    v_mul_u32_u24 v128, 5120, v120
    v_add_u32 v160, 122112, v128
    v_add_u32 v161, 123392, v128
    v_add_u32 v162, 124672, v128
    v_add_u32 v163, 125952, v128
    v_add_u32 v128, 126464, v128
    s_sub_u32 s44, 4294966016, s37
    s_sub_u32 s45, 4294964736, s37
    s_sub_u32 s46, 4294963456, s37
    v_subrev_u32 v122, s44, v125
    v_subrev_u32 v123, s46, v125
    s_movk_i32 s47, 1280
    s_movk_i32 s48, 1024
    v_add_u32 v234, s37, v234
    v_add_u32 v235, s37, v235
    s_add_u32 s10, s37, 7
    v_add_u32 v236, s10, v236
    v_add3_u32 v237, v237, v124, s10
    s_waitcnt lgkmcnt(0)
    v_readfirstlane_b32 s10, v130
    s_cmp_eq_u32 s10, 64
    s_cbranch_scc1 M_rdy
M_spin:
    s_sleep 1
    ds_read_b32 v130, v121 offset:1024
    ds_read_b128 v[132:135], v121 offset:5120
    ds_read_b128 v[164:167], v131 offset:5120
    ds_read_b32 v129, v121 offset:5136
    s_waitcnt lgkmcnt(0)
    v_readfirstlane_b32 s10, v130
    s_cmp_eq_u32 s10, 64
    s_cbranch_scc0 M_spin
M_rdy:
    ds_read2_b64 v[136:139], v122 offset0:0 offset1:64
    ds_read2_b64 v[140:143], v122 offset0:160 offset1:224
    ds_read2_b64 v[144:147], v123 offset0:0 offset1:64
    v_sub_u32 v160, v132, v160
    v_sub_u32 v161, v133, v161
    v_sub_u32 v162, v134, v162
    v_sub_u32 v163, v135, v163
    v_add_u32 v164, v164, v125
    v_add3_u32 v132, v132, v161, v162
    v_max3_u32 v161, v161, v162, v163
    v_add3_u32 v165, v164, v165, s44
    v_add_u32 v132, v132, v163
    v_max_u32 v160, v160, v161
    v_add3_u32 v166, v165, v166, s45
    v_cmp_lt_u32 vcc, v128, v132
    v_cmp_lt_u32 s[40:41], s47, v160
    v_add3_u32 v167, v166, v167, s46
    v_readfirstlane_b32 s10, v129
    v_cmp_lt_u32 s[42:43], s48, v161
    s_or_b32 s11, vcc_lo, s40
    v_readfirstlane_b32 s30, v167
    s_or_b32 s11, s11, s10
    s_cbranch_scc1 M_slowinit
M_cont:
    s_cmp_eq_u32 s42, 0
    s_cbranch_scc1 M_notail
    s_mov_b32 exec_hi, 0
    ds_read_b64 v[152:153], v122 offset:1024
    ds_read_b64 v[154:155], v122 offset:2304
    ds_read_b64 v[156:157], v123 offset:1024
    s_waitcnt lgkmcnt(0)
    ds_write_b64 v164, v[152:153] offset:1024
    ds_write_b64 v165, v[154:155] offset:1024
    ds_write_b64 v166, v[156:157] offset:1024
    s_mov_b32 exec_hi, -1
M_notail:
    s_sub_u32 s30, s30, s37
    s_waitcnt lgkmcnt(0)
    ds_write2_b64 v164, v[136:137], v[138:139] offset0:0 offset1:64
    ds_write2_b64 v165, v[140:141], v[142:143] offset0:0 offset1:64
    ds_write2_b64 v166, v[144:145], v[146:147] offset0:0 offset1:64
    ds_write2_b64 v167, v[126:127], v[126:127] offset0:0 offset1:32
    s_add_u32 s61, s30, 127
    s_lshr_b32 s61, s61, 7
    s_add_u32 s30, s30, 255
    s_lshr_b32 s30, s30, 8
    s_xor_b32 s11, s29, 1
    v_readlane_b32 s100, v132, s11
    s_mul_i32 s11, s11, 5120
    s_sub_u32 s100, s100, s11
    s_sub_u32 s100, s100, 121985
    s_lshr_b32 s100, s100, 7
    s_lshr_b32 s11, s28, 2
    s_cmp_eq_u32 s11, 0
    s_cselect_b32 s11, 99, 0
    s_add_i32 s100, s100, s11
    s_cmp_ge_i32 s61, s100
    s_cselect_b32 s100, 1, 0
    s_lshr_b32 s10, s28, 2
    s_cmp_eq_u32 s10, 1
    s_cbranch_scc0 M_fill0
    s_setprio 3
M_fill0:
    s_cmp_eq_u32 s101, 0
    s_cbranch_scc1 M_ea4
    s_waitcnt lgkmcnt(0)
    s_branch M_ea5
M_ea4:
    ds_read_b64 v[246:247], v235 offset:0
    ds_read_u16 v212, v234 offset:0
    ds_read_u16 v214, v234 offset:64
    ds_read_u16 v216, v234 offset:128
    ds_read_u16 v218, v234 offset:192
    s_waitcnt lgkmcnt(4)
    v_bfe_u32 v220, v246, 16, 12
    v_mad_u32_u24 v220, v247, 1, v220
    s_add_u32 m0, s32, 0
    s_nop 0
    buffer_load_dwordx4 v[220:221], s[16:19], 0 idxen offen  lds
    s_add_u32 m0, s31, 0
    s_waitcnt lgkmcnt(3)
    s_nop 0
    buffer_load_dwordx4 v[212:213], s[12:15], 0 idxen offen lds
    s_add_u32 m0, s31, 1024
    s_waitcnt lgkmcnt(2)
    s_nop 0
    buffer_load_dwordx4 v[214:215], s[12:15], 0 idxen offen lds
    s_add_u32 m0, s31, 2048
    s_waitcnt lgkmcnt(1)
    s_nop 0
    buffer_load_dwordx4 v[216:217], s[12:15], 0 idxen offen lds
    s_add_u32 m0, s31, 3072
    s_waitcnt lgkmcnt(0)
    s_nop 0
    buffer_load_dwordx4 v[218:219], s[12:15], 0 idxen offen lds
M_ea5:
    v_pk_mul_f32 v[88:89], v[88:89], s[8:9] op_sel_hi:[1,0]
    v_pk_mul_f32 v[90:91], v[90:91], s[8:9] op_sel_hi:[1,0]
    v_pk_mul_f32 v[92:93], v[92:93], s[8:9] op_sel_hi:[1,0]
    v_pk_mul_f32 v[94:95], v[94:95], s[8:9] op_sel_hi:[1,0]
    v_pk_mul_f32 v[96:97], v[96:97], s[8:9] op_sel_hi:[1,0]
    v_pk_mul_f32 v[98:99], v[98:99], s[8:9] op_sel_hi:[1,0]
    v_pk_mul_f32 v[100:101], v[100:101], s[8:9] op_sel_hi:[1,0]
    v_pk_mul_f32 v[102:103], v[102:103], s[8:9] op_sel_hi:[1,0]
    v_pk_mul_f32 v[104:105], v[104:105], s[8:9] op_sel_hi:[1,0]
    v_pk_mul_f32 v[106:107], v[106:107], s[8:9] op_sel_hi:[1,0]
    v_pk_mul_f32 v[108:109], v[108:109], s[8:9] op_sel_hi:[1,0]
    v_pk_mul_f32 v[110:111], v[110:111], s[8:9] op_sel_hi:[1,0]
    v_pk_mul_f32 v[112:113], v[112:113], s[8:9] op_sel_hi:[1,0]
    v_pk_mul_f32 v[114:115], v[114:115], s[8:9] op_sel_hi:[1,0]
    v_pk_mul_f32 v[116:117], v[116:117], s[8:9] op_sel_hi:[1,0]
    v_pk_mul_f32 v[118:119], v[118:119], s[8:9] op_sel_hi:[1,0]
    s_mov_b32 s8, 1.0
    s_cmp_eq_u32 s30, 0
    s_cbranch_scc1 M_exit
    ds_read_u8 v222, v236 offset:0
    ds_read_u8 v224, v237 offset:0
    ds_read_u8 v225, v237 offset:32
    ds_read_u8 v226, v237 offset:128
    ds_read_u8 v227, v237 offset:160
    ds_read_b64 v[246:247], v235 offset:256
    ds_read_u16 v212, v234 offset:256
    ds_read_u16 v214, v234 offset:320
    ds_read_u16 v216, v234 offset:384
    ds_read_u16 v218, v234 offset:448
    v_mov_b32 v152, 0
    v_mov_b32 v153, 0
    v_mov_b32 v154, 0
    v_mov_b32 v155, 0
    v_mov_b32 v156, 0
    v_mov_b32 v157, 0
    v_mov_b32 v158, 0
    v_mov_b32 v159, 0
    v_mov_b32 v160, 0
    v_mov_b32 v161, 0
    v_mov_b32 v162, 0
    v_mov_b32 v163, 0
    v_mov_b32 v164, 0
    v_mov_b32 v165, 0
    v_mov_b32 v166, 0
    v_mov_b32 v167, 0
    v_mov_b32 v196, 0
    v_mov_b32 v197, 0
    v_mov_b32 v198, 0
    v_mov_b32 v199, 0
    v_mov_b32 v200, 0
    v_mov_b32 v201, 0
    v_mov_b32 v202, 0
    v_mov_b32 v203, 0
    v_mov_b32 v120, 0
    v_mov_b32 v121, 0
    v_mov_b32 v122, 0
    v_mov_b32 v123, 0
    v_mov_b32 v124, 0
    v_mov_b32 v125, 0
    v_mov_b32 v126, 0
    v_mov_b32 v127, 0
    v_mov_b32 v128, 0
    v_mov_b32 v129, 0
    v_mov_b32 v130, 0
    v_mov_b32 v131, 0
    v_mov_b32 v132, 0
    v_mov_b32 v133, 0
    v_mov_b32 v134, 0
    v_mov_b32 v135, 0
    v_mov_b32 v188, v223
    v_mov_b32 v189, v223
    v_mov_b32 v190, v223
    v_mov_b32 v191, v223
    s_waitcnt lgkmcnt(5)
    v_lshrrev_b32 v192, 4, v222
    v_lshlrev_b16 v192, v222, v192
    v_mad_u32_u24 v224, v224, s75, v228
    v_mad_u32_u24 v225, v225, s75, v228
    v_mad_u32_u24 v226, v226, s75, v228
    v_mad_u32_u24 v227, v227, s75, v228
    s_waitcnt lgkmcnt(4)
    v_bfe_u32 v220, v246, 16, 12
    v_mad_u32_u24 v220, v247, 1, v220
    v_smfmac_f32_32x32x32_bf16 v[120:135], v[188:191], v[72:79], v192
    s_waitcnt vmcnt(0)
    ds_read_b128 v[184:187], v233 offset:0
    ds_read_b128 v[168:171], v229 offset:0
    ds_read_b128 v[172:175], v230 offset:0
    ds_read_b128 v[176:179], v231 offset:0
    ds_read_b128 v[180:183], v232 offset:0
    s_waitcnt lgkmcnt(4)
    v_mfma_f32_32x32x16_bf16 v[120:135], v[184:187], v[64:67], v[120:135]
    s_waitcnt lgkmcnt(3)
    v_mfma_f32_32x32x16_bf16 v[120:135], v[168:171], v[0:3], v[120:135]
    s_waitcnt lgkmcnt(2)
    v_mfma_f32_32x32x16_bf16 v[120:135], v[172:175], v[8:11], v[120:135]
    s_waitcnt lgkmcnt(1)
    v_mfma_f32_32x32x16_bf16 v[120:135], v[176:179], v[16:19], v[120:135]
    s_waitcnt lgkmcnt(0)
    v_mfma_f32_32x32x16_bf16 v[120:135], v[180:183], v[24:27], v[120:135]
    s_add_u32 m0, s32, 1024
    s_nop 0
    buffer_load_dwordx4 v[220:221], s[16:19], 0 idxen offen  lds
    s_add_u32 m0, s31, 32768
    s_nop 0
    buffer_load_dwordx4 v[212:213], s[12:15], 0 idxen offen lds
    s_add_u32 m0, s31, 33792
    s_nop 0
    buffer_load_dwordx4 v[214:215], s[12:15], 0 idxen offen lds
    s_add_u32 m0, s31, 34816
    s_nop 0
    buffer_load_dwordx4 v[216:217], s[12:15], 0 idxen offen lds
    s_add_u32 m0, s31, 35840
    s_nop 0
    buffer_load_dwordx4 v[218:219], s[12:15], 0 idxen offen lds
    s_sub_u32 s30, s30, 1
    s_cmp_eq_u32 s30, 0
    s_cbranch_scc1 M_drain
    s_cmp_lg_u32 s100, 0
    s_cbranch_scc1 M_loopb
    s_branch M_pq1
.p2align 12
M_pp1:
    s_branch M_pback
M_pq1:
M_loop:
    s_setprio 1
    v_mfma_f32_32x32x16_bf16 v[136:151], v[184:187], v[68:71], 0
    ds_read_u8 v222, v236 offset:256
    v_exp_f32 v120, v120
    v_exp_f32 v121, v121
    v_exp_f32 v122, v122
    v_smfmac_f32_32x32x32_bf16 v[104:119], v[196:199], v[152:159], v204
    v_exp_f32 v123, v123
    v_exp_f32 v124, v124
    v_exp_f32 v125, v125
    v_smfmac_f32_32x32x32_bf16 v[104:119], v[200:203], v[160:167], v204
    ds_read_b64_tr_b16 v[196:197], v224
    ds_read_b64_tr_b16 v[198:199], v225
    ds_read_b64_tr_b16 v[200:201], v226
    ds_read_b64_tr_b16 v[202:203], v227
    v_exp_f32 v126, v126
    v_exp_f32 v127, v127
    v_exp_f32 v128, v128
    v_mfma_f32_32x32x16_bf16 v[152:167], v[168:171], v[32:35], 0
    v_exp_f32 v129, v129
    v_exp_f32 v130, v130
    v_exp_f32 v131, v131
    v_mfma_f32_32x32x16_bf16 v[152:167], v[172:175], v[40:43], v[152:167]
    v_exp_f32 v132, v132
    v_exp_f32 v133, v133
    v_mfma_f32_32x32x16_bf16 v[152:167], v[176:179], v[48:51], v[152:167]
    v_exp_f32 v134, v134
    v_exp_f32 v135, v135
    v_mfma_f32_32x32x16_bf16 v[152:167], v[180:183], v[56:59], v[152:167]
    s_setprio 0
    v_add_f32 v120, 1.0, v120
    v_add_f32 v121, 1.0, v121
    v_add_f32 v122, 1.0, v122
    v_add_f32 v123, 1.0, v123
    v_add_f32 v124, 1.0, v124
    v_add_f32 v125, 1.0, v125
    v_add_f32 v126, 1.0, v126
    v_add_f32 v127, 1.0, v127
    v_add_f32 v128, 1.0, v128
    v_add_f32 v129, 1.0, v129
    v_add_f32 v130, 1.0, v130
    v_add_f32 v131, 1.0, v131
    v_add_f32 v132, 1.0, v132
    v_add_f32 v133, 1.0, v133
    v_add_f32 v134, 1.0, v134
    v_add_f32 v135, 1.0, v135
    s_waitcnt lgkmcnt(4)
    s_setprio 1
    v_smfmac_f32_32x32x32_bf16 v[136:151], v[188:191], v[80:87], v192
    s_waitcnt vmcnt(4)
    ds_read_b128 v[184:187], v233 offset:1024
    ds_read_b64 v[246:247], v235 offset:512
    ds_read_u16 v212, v234 offset:512
    ds_read_u16 v214, v234 offset:576
    ds_read_u16 v216, v234 offset:640
    ds_read_u16 v218, v234 offset:704
    v_rcp_f32 v120, v120
    v_rcp_f32 v121, v121
    v_rcp_f32 v122, v122
    v_mfma_f32_32x32x16_bf16 v[136:151], v[168:171], v[4:7], v[136:151]
    v_rcp_f32 v123, v123
    v_rcp_f32 v124, v124
    v_rcp_f32 v125, v125
    v_mfma_f32_32x32x16_bf16 v[136:151], v[172:175], v[12:15], v[136:151]
    v_rcp_f32 v126, v126
    v_rcp_f32 v127, v127
    v_rcp_f32 v128, v128
    v_mfma_f32_32x32x16_bf16 v[136:151], v[176:179], v[20:23], v[136:151]
    v_rcp_f32 v129, v129
    v_rcp_f32 v130, v130
    v_rcp_f32 v131, v131
    v_mfma_f32_32x32x16_bf16 v[136:151], v[180:183], v[28:31], v[136:151]
    v_rcp_f32 v132, v132
    v_rcp_f32 v133, v133
    v_rcp_f32 v134, v134
    v_rcp_f32 v135, v135
    s_setprio 0
    v_lshrrev_b32 v192, 4, v222
    v_lshlrev_b16 v192, v222, v192
    v_mul_f32 v152, v152, v120
    v_mul_f32 v153, v153, v121
    v_mul_f32 v154, v154, v122
    v_mul_f32 v155, v155, v123
    v_mul_f32 v156, v156, v124
    v_mul_f32 v157, v157, v125
    v_mul_f32 v158, v158, v126
    v_mul_f32 v159, v159, v127
    v_mul_f32 v160, v160, v128
    v_mul_f32 v161, v161, v129
    v_mul_f32 v162, v162, v130
    v_mul_f32 v163, v163, v131
    v_mul_f32 v164, v164, v132
    v_mul_f32 v165, v165, v133
    v_mul_f32 v166, v166, v134
    v_mul_f32 v167, v167, v135
    s_waitcnt lgkmcnt(4)
    v_bfe_u32 v220, v246, 16, 12
    v_mad_u32_u24 v220, v247, 1, v220
    s_setprio 1
    v_mfma_f32_32x32x16_bf16 v[120:135], v[184:187], v[64:67], 0
    ds_read_u8 v224, v237 offset:256
    ds_read_u8 v225, v237 offset:288
    ds_read_u8 v226, v237 offset:384
    ds_read_u8 v227, v237 offset:416
    v_exp_f32 v136, v136
    v_exp_f32 v137, v137
    v_exp_f32 v138, v138
    v_smfmac_f32_32x32x32_bf16 v[88:103], v[196:199], v[152:159], v204
    v_exp_f32 v139, v139
    v_exp_f32 v140, v140
    v_exp_f32 v141, v141
    v_smfmac_f32_32x32x32_bf16 v[88:103], v[200:203], v[160:167], v204
    v_exp_f32 v142, v142
    v_exp_f32 v143, v143
    v_exp_f32 v144, v144
    s_waitcnt vmcnt(0)
    v_mfma_f32_32x32x16_bf16 v[152:167], v[168:171], v[36:39], 0
    ds_read_b128 v[168:171], v229 offset:32768
    v_exp_f32 v145, v145
    v_exp_f32 v146, v146
    v_exp_f32 v147, v147
    v_mfma_f32_32x32x16_bf16 v[152:167], v[172:175], v[44:47], v[152:167]
    ds_read_b128 v[172:175], v230 offset:32768
    v_exp_f32 v148, v148
    v_exp_f32 v149, v149
    v_mfma_f32_32x32x16_bf16 v[152:167], v[176:179], v[52:55], v[152:167]
    ds_read_b128 v[176:179], v231 offset:32768
    v_exp_f32 v150, v150
    v_exp_f32 v151, v151
    v_mfma_f32_32x32x16_bf16 v[152:167], v[180:183], v[60:63], v[152:167]
    ds_read_b128 v[180:183], v232 offset:32768
    s_setprio 0
    v_add_f32 v136, 1.0, v136
    v_add_f32 v137, 1.0, v137
    v_add_f32 v138, 1.0, v138
    v_add_f32 v139, 1.0, v139
    v_add_f32 v140, 1.0, v140
    v_add_f32 v141, 1.0, v141
    v_add_f32 v142, 1.0, v142
    v_add_f32 v143, 1.0, v143
    v_add_f32 v144, 1.0, v144
    v_add_f32 v145, 1.0, v145
    v_add_f32 v146, 1.0, v146
    v_add_f32 v147, 1.0, v147
    v_add_f32 v148, 1.0, v148
    v_add_f32 v149, 1.0, v149
    v_add_f32 v150, 1.0, v150
    v_add_f32 v151, 1.0, v151
    s_setprio 1
    v_smfmac_f32_32x32x32_bf16 v[120:135], v[188:191], v[72:79], v192
    v_rcp_f32 v136, v136
    v_rcp_f32 v137, v137
    v_rcp_f32 v138, v138
    s_waitcnt lgkmcnt(3)
    v_mfma_f32_32x32x16_bf16 v[120:135], v[168:171], v[0:3], v[120:135]
    v_rcp_f32 v139, v139
    v_rcp_f32 v140, v140
    v_rcp_f32 v141, v141
    s_waitcnt lgkmcnt(2)
    v_mfma_f32_32x32x16_bf16 v[120:135], v[172:175], v[8:11], v[120:135]
    v_rcp_f32 v142, v142
    v_rcp_f32 v143, v143
    v_rcp_f32 v144, v144
    s_waitcnt lgkmcnt(1)
    v_mfma_f32_32x32x16_bf16 v[120:135], v[176:179], v[16:19], v[120:135]
    v_rcp_f32 v145, v145
    v_rcp_f32 v146, v146
    v_rcp_f32 v147, v147
    s_waitcnt lgkmcnt(0)
    v_mfma_f32_32x32x16_bf16 v[120:135], v[180:183], v[24:27], v[120:135]
    s_add_u32 m0, s32, 0
    v_rcp_f32 v148, v148
    buffer_load_dwordx4 v[220:221], s[16:19], 0 idxen offen  lds
    s_add_u32 m0, s31, 0
    v_rcp_f32 v149, v149
    buffer_load_dwordx4 v[212:213], s[12:15], 0 idxen offen lds
    s_add_u32 m0, s31, 1024
    v_rcp_f32 v150, v150
    buffer_load_dwordx4 v[214:215], s[12:15], 0 idxen offen lds
    s_add_u32 m0, s31, 2048
    v_rcp_f32 v151, v151
    buffer_load_dwordx4 v[216:217], s[12:15], 0 idxen offen lds
    s_add_u32 m0, s31, 3072
    s_nop 0
    buffer_load_dwordx4 v[218:219], s[12:15], 0 idxen offen lds
    s_setprio 0
    v_mad_u32_u24 v224, v224, s75, v228
    v_mad_u32_u24 v225, v225, s75, v228
    v_mad_u32_u24 v226, v226, s75, v228
    v_mad_u32_u24 v227, v227, s75, v228
    v_mul_f32 v152, v152, v136
    v_mul_f32 v153, v153, v137
    v_mul_f32 v154, v154, v138
    v_mul_f32 v155, v155, v139
    v_mul_f32 v156, v156, v140
    v_mul_f32 v157, v157, v141
    v_mul_f32 v158, v158, v142
    v_mul_f32 v159, v159, v143
    v_mul_f32 v160, v160, v144
    v_mul_f32 v161, v161, v145
    v_mul_f32 v162, v162, v146
    v_mul_f32 v163, v163, v147
    v_mul_f32 v164, v164, v148
    v_mul_f32 v165, v165, v149
    v_mul_f32 v166, v166, v150
    v_mul_f32 v167, v167, v151
    s_sub_u32 s30, s30, 1
    s_cmp_eq_u32 s30, 0
    s_cbranch_scc1 M_drain
    s_setprio 1
    v_mfma_f32_32x32x16_bf16 v[136:151], v[184:187], v[68:71], 0
    ds_read_u8 v222, v236 offset:512
    v_exp_f32 v120, v120
    v_exp_f32 v121, v121
    v_exp_f32 v122, v122
    v_smfmac_f32_32x32x32_bf16 v[104:119], v[196:199], v[152:159], v204
    v_exp_f32 v123, v123
    v_exp_f32 v124, v124
    v_exp_f32 v125, v125
    v_smfmac_f32_32x32x32_bf16 v[104:119], v[200:203], v[160:167], v204
    ds_read_b64_tr_b16 v[196:197], v224
    ds_read_b64_tr_b16 v[198:199], v225
    ds_read_b64_tr_b16 v[200:201], v226
    ds_read_b64_tr_b16 v[202:203], v227
    v_exp_f32 v126, v126
    v_exp_f32 v127, v127
    v_exp_f32 v128, v128
    v_mfma_f32_32x32x16_bf16 v[152:167], v[168:171], v[32:35], 0
    v_exp_f32 v129, v129
    v_exp_f32 v130, v130
    v_exp_f32 v131, v131
    v_mfma_f32_32x32x16_bf16 v[152:167], v[172:175], v[40:43], v[152:167]
    v_exp_f32 v132, v132
    v_exp_f32 v133, v133
    v_mfma_f32_32x32x16_bf16 v[152:167], v[176:179], v[48:51], v[152:167]
    v_exp_f32 v134, v134
    v_exp_f32 v135, v135
    v_mfma_f32_32x32x16_bf16 v[152:167], v[180:183], v[56:59], v[152:167]
    s_setprio 0
    v_add_f32 v120, 1.0, v120
    v_add_f32 v121, 1.0, v121
    v_add_f32 v122, 1.0, v122
    v_add_f32 v123, 1.0, v123
    v_add_f32 v124, 1.0, v124
    v_add_f32 v125, 1.0, v125
    v_add_f32 v126, 1.0, v126
    v_add_f32 v127, 1.0, v127
    v_add_f32 v128, 1.0, v128
    v_add_f32 v129, 1.0, v129
    v_add_f32 v130, 1.0, v130
    v_add_f32 v131, 1.0, v131
    v_add_f32 v132, 1.0, v132
    v_add_f32 v133, 1.0, v133
    v_add_f32 v134, 1.0, v134
    v_add_f32 v135, 1.0, v135
    s_waitcnt lgkmcnt(4)
    s_setprio 1
    v_smfmac_f32_32x32x32_bf16 v[136:151], v[188:191], v[80:87], v192
    s_waitcnt vmcnt(4)
    ds_read_b128 v[184:187], v233 offset:0
    ds_read_b64 v[246:247], v235 offset:768
    ds_read_u16 v212, v234 offset:768
    ds_read_u16 v214, v234 offset:832
    ds_read_u16 v216, v234 offset:896
    ds_read_u16 v218, v234 offset:960
    v_rcp_f32 v120, v120
    v_rcp_f32 v121, v121
    v_rcp_f32 v122, v122
    v_mfma_f32_32x32x16_bf16 v[136:151], v[168:171], v[4:7], v[136:151]
    v_rcp_f32 v123, v123
    v_rcp_f32 v124, v124
    v_rcp_f32 v125, v125
    v_mfma_f32_32x32x16_bf16 v[136:151], v[172:175], v[12:15], v[136:151]
    v_rcp_f32 v126, v126
    v_rcp_f32 v127, v127
    v_rcp_f32 v128, v128
    v_mfma_f32_32x32x16_bf16 v[136:151], v[176:179], v[20:23], v[136:151]
    v_rcp_f32 v129, v129
    v_rcp_f32 v130, v130
    v_rcp_f32 v131, v131
    v_mfma_f32_32x32x16_bf16 v[136:151], v[180:183], v[28:31], v[136:151]
    v_rcp_f32 v132, v132
    v_rcp_f32 v133, v133
    v_rcp_f32 v134, v134
    v_rcp_f32 v135, v135
    s_setprio 0
    v_lshrrev_b32 v192, 4, v222
    v_lshlrev_b16 v192, v222, v192
    v_mul_f32 v152, v152, v120
    v_mul_f32 v153, v153, v121
    v_mul_f32 v154, v154, v122
    v_mul_f32 v155, v155, v123
    v_mul_f32 v156, v156, v124
    v_mul_f32 v157, v157, v125
    v_mul_f32 v158, v158, v126
    v_mul_f32 v159, v159, v127
    v_mul_f32 v160, v160, v128
    v_mul_f32 v161, v161, v129
    v_mul_f32 v162, v162, v130
    v_mul_f32 v163, v163, v131
    v_mul_f32 v164, v164, v132
    v_mul_f32 v165, v165, v133
    v_mul_f32 v166, v166, v134
    v_mul_f32 v167, v167, v135
    s_waitcnt lgkmcnt(4)
    v_bfe_u32 v220, v246, 16, 12
    v_mad_u32_u24 v220, v247, 1, v220
    s_setprio 1
    v_mfma_f32_32x32x16_bf16 v[120:135], v[184:187], v[64:67], 0
    ds_read_u8 v224, v237 offset:512
    ds_read_u8 v225, v237 offset:544
    ds_read_u8 v226, v237 offset:640
    ds_read_u8 v227, v237 offset:672
    v_exp_f32 v136, v136
    v_exp_f32 v137, v137
    v_exp_f32 v138, v138
    v_smfmac_f32_32x32x32_bf16 v[88:103], v[196:199], v[152:159], v204
    v_exp_f32 v139, v139
    v_exp_f32 v140, v140
    v_exp_f32 v141, v141
    v_smfmac_f32_32x32x32_bf16 v[88:103], v[200:203], v[160:167], v204
    v_exp_f32 v142, v142
    v_exp_f32 v143, v143
    v_exp_f32 v144, v144
    s_waitcnt vmcnt(0)
    v_mfma_f32_32x32x16_bf16 v[152:167], v[168:171], v[36:39], 0
    ds_read_b128 v[168:171], v229 offset:0
    v_exp_f32 v145, v145
    v_exp_f32 v146, v146
    v_exp_f32 v147, v147
    v_mfma_f32_32x32x16_bf16 v[152:167], v[172:175], v[44:47], v[152:167]
    ds_read_b128 v[172:175], v230 offset:0
    v_exp_f32 v148, v148
    v_exp_f32 v149, v149
    v_mfma_f32_32x32x16_bf16 v[152:167], v[176:179], v[52:55], v[152:167]
    ds_read_b128 v[176:179], v231 offset:0
    v_exp_f32 v150, v150
    v_exp_f32 v151, v151
    v_mfma_f32_32x32x16_bf16 v[152:167], v[180:183], v[60:63], v[152:167]
    ds_read_b128 v[180:183], v232 offset:0
    s_setprio 0
    v_add_f32 v136, 1.0, v136
    v_add_f32 v137, 1.0, v137
    v_add_f32 v138, 1.0, v138
    v_add_f32 v139, 1.0, v139
    v_add_f32 v140, 1.0, v140
    v_add_f32 v141, 1.0, v141
    v_add_f32 v142, 1.0, v142
    v_add_f32 v143, 1.0, v143
    v_add_f32 v144, 1.0, v144
    v_add_f32 v145, 1.0, v145
    v_add_f32 v146, 1.0, v146
    v_add_f32 v147, 1.0, v147
    v_add_f32 v148, 1.0, v148
    v_add_f32 v149, 1.0, v149
    v_add_f32 v150, 1.0, v150
    v_add_f32 v151, 1.0, v151
    s_setprio 1
    v_smfmac_f32_32x32x32_bf16 v[120:135], v[188:191], v[72:79], v192
    v_rcp_f32 v136, v136
    v_rcp_f32 v137, v137
    v_rcp_f32 v138, v138
    s_waitcnt lgkmcnt(3)
    v_mfma_f32_32x32x16_bf16 v[120:135], v[168:171], v[0:3], v[120:135]
    v_rcp_f32 v139, v139
    v_rcp_f32 v140, v140
    v_rcp_f32 v141, v141
    s_waitcnt lgkmcnt(2)
    v_mfma_f32_32x32x16_bf16 v[120:135], v[172:175], v[8:11], v[120:135]
    v_rcp_f32 v142, v142
    v_rcp_f32 v143, v143
    v_rcp_f32 v144, v144
    s_waitcnt lgkmcnt(1)
    v_mfma_f32_32x32x16_bf16 v[120:135], v[176:179], v[16:19], v[120:135]
    v_rcp_f32 v145, v145
    v_rcp_f32 v146, v146
    v_rcp_f32 v147, v147
    s_waitcnt lgkmcnt(0)
    v_mfma_f32_32x32x16_bf16 v[120:135], v[180:183], v[24:27], v[120:135]
    s_add_u32 m0, s32, 1024
    v_rcp_f32 v148, v148
    buffer_load_dwordx4 v[220:221], s[16:19], 0 idxen offen  lds
    s_add_u32 m0, s31, 32768
    v_rcp_f32 v149, v149
    buffer_load_dwordx4 v[212:213], s[12:15], 0 idxen offen lds
    s_add_u32 m0, s31, 33792
    v_rcp_f32 v150, v150
    buffer_load_dwordx4 v[214:215], s[12:15], 0 idxen offen lds
    s_add_u32 m0, s31, 34816
    v_rcp_f32 v151, v151
    buffer_load_dwordx4 v[216:217], s[12:15], 0 idxen offen lds
    s_add_u32 m0, s31, 35840
    s_nop 0
    buffer_load_dwordx4 v[218:219], s[12:15], 0 idxen offen lds
    s_setprio 0
    v_mad_u32_u24 v224, v224, s75, v228
    v_mad_u32_u24 v225, v225, s75, v228
    v_mad_u32_u24 v226, v226, s75, v228
    v_mad_u32_u24 v227, v227, s75, v228
    v_add_u32 v234, 512, v234
    v_add_u32 v235, 512, v235
    v_add_u32 v236, 512, v236
    v_add_u32 v237, 512, v237
    v_mul_f32 v152, v152, v136
    v_mul_f32 v153, v153, v137
    v_mul_f32 v154, v154, v138
    v_mul_f32 v155, v155, v139
    v_mul_f32 v156, v156, v140
    v_mul_f32 v157, v157, v141
    v_mul_f32 v158, v158, v142
    v_mul_f32 v159, v159, v143
    v_mul_f32 v160, v160, v144
    v_mul_f32 v161, v161, v145
    v_mul_f32 v162, v162, v146
    v_mul_f32 v163, v163, v147
    v_mul_f32 v164, v164, v148
    v_mul_f32 v165, v165, v149
    v_mul_f32 v166, v166, v150
    v_mul_f32 v167, v167, v151
    s_sub_u32 s30, s30, 1
    s_cmp_lg_u32 s30, 0
    s_cbranch_scc1 M_loop
M_drain:
    s_bitcmp1_b32 s61, 0
    s_cbranch_scc1 M_half
    s_setprio 1
    v_mfma_f32_32x32x16_bf16 v[136:151], v[184:187], v[68:71], 0
    v_exp_f32 v120, v120
    v_exp_f32 v121, v121
    v_exp_f32 v122, v122
    v_exp_f32 v123, v123
    v_smfmac_f32_32x32x32_bf16 v[104:119], v[196:199], v[152:159], v204
    v_exp_f32 v124, v124
    v_exp_f32 v125, v125
    v_exp_f32 v126, v126
    v_exp_f32 v127, v127
    v_smfmac_f32_32x32x32_bf16 v[104:119], v[200:203], v[160:167], v204
    ds_read_b64_tr_b16 v[196:197], v224
    ds_read_b64_tr_b16 v[198:199], v225
    ds_read_b64_tr_b16 v[200:201], v226
    ds_read_b64_tr_b16 v[202:203], v227
    v_exp_f32 v128, v128
    v_exp_f32 v129, v129
    v_exp_f32 v130, v130
    v_exp_f32 v131, v131
    v_mfma_f32_32x32x16_bf16 v[152:167], v[168:171], v[32:35], 0
    v_exp_f32 v132, v132
    v_exp_f32 v133, v133
    v_exp_f32 v134, v134
    v_exp_f32 v135, v135
    v_add_f32 v120, 1.0, v120
    v_mfma_f32_32x32x16_bf16 v[152:167], v[172:175], v[40:43], v[152:167]
    v_add_f32 v121, 1.0, v121
    v_add_f32 v122, 1.0, v122
    v_add_f32 v123, 1.0, v123
    v_add_f32 v124, 1.0, v124
    v_add_f32 v125, 1.0, v125
    v_add_f32 v126, 1.0, v126
    v_add_f32 v127, 1.0, v127
    v_add_f32 v128, 1.0, v128
    v_add_f32 v129, 1.0, v129
    v_mfma_f32_32x32x16_bf16 v[152:167], v[176:179], v[48:51], v[152:167]
    v_add_f32 v130, 1.0, v130
    v_add_f32 v131, 1.0, v131
    v_add_f32 v132, 1.0, v132
    v_add_f32 v133, 1.0, v133
    v_add_f32 v134, 1.0, v134
    v_add_f32 v135, 1.0, v135
    v_rcp_f32 v120, v120
    v_mfma_f32_32x32x16_bf16 v[152:167], v[180:183], v[56:59], v[152:167]
    v_rcp_f32 v121, v121
    v_rcp_f32 v122, v122
    v_rcp_f32 v123, v123
    v_rcp_f32 v124, v124
    v_smfmac_f32_32x32x32_bf16 v[136:151], v[188:191], v[80:87], v192
    v_rcp_f32 v125, v125
    v_rcp_f32 v126, v126
    v_rcp_f32 v127, v127
    v_rcp_f32 v128, v128
    v_mfma_f32_32x32x16_bf16 v[136:151], v[168:171], v[4:7], v[136:151]
    v_rcp_f32 v129, v129
    v_rcp_f32 v130, v130
    v_rcp_f32 v131, v131
    v_rcp_f32 v132, v132
    v_mfma_f32_32x32x16_bf16 v[136:151], v[172:175], v[12:15], v[136:151]
    v_rcp_f32 v133, v133
    v_rcp_f32 v134, v134
    v_rcp_f32 v135, v135
    v_mul_f32 v152, v152, v120
    v_mul_f32 v153, v153, v121
    v_mul_f32 v154, v154, v122
    v_mfma_f32_32x32x16_bf16 v[136:151], v[176:179], v[20:23], v[136:151]
    v_mul_f32 v155, v155, v123
    v_mul_f32 v156, v156, v124
    v_mul_f32 v157, v157, v125
    v_mul_f32 v158, v158, v126
    v_mul_f32 v159, v159, v127
    v_mul_f32 v160, v160, v128
    v_mul_f32 v161, v161, v129
    v_mul_f32 v162, v162, v130
    v_mul_f32 v163, v163, v131
    v_mfma_f32_32x32x16_bf16 v[136:151], v[180:183], v[28:31], v[136:151]
    v_mul_f32 v164, v164, v132
    v_mul_f32 v165, v165, v133
    v_mul_f32 v166, v166, v134
    v_mul_f32 v167, v167, v135
    s_waitcnt lgkmcnt(2)
    v_smfmac_f32_32x32x32_bf16 v[88:103], v[196:199], v[152:159], v204
    s_waitcnt lgkmcnt(0)
    v_smfmac_f32_32x32x32_bf16 v[88:103], v[200:203], v[160:167], v204
    s_nop 3
    v_exp_f32 v136, v136
    v_exp_f32 v137, v137
    v_exp_f32 v138, v138
    v_exp_f32 v139, v139
    v_exp_f32 v140, v140
    v_mfma_f32_32x32x16_bf16 v[152:167], v[168:171], v[36:39], 0
    v_exp_f32 v141, v141
    v_exp_f32 v142, v142
    v_exp_f32 v143, v143
    v_exp_f32 v144, v144
    v_exp_f32 v145, v145
    v_exp_f32 v146, v146
    v_mfma_f32_32x32x16_bf16 v[152:167], v[172:175], v[44:47], v[152:167]
    v_exp_f32 v147, v147
    v_exp_f32 v148, v148
    v_exp_f32 v149, v149
    v_exp_f32 v150, v150
    v_exp_f32 v151, v151
    v_add_f32 v136, 1.0, v136
    v_add_f32 v137, 1.0, v137
    v_add_f32 v138, 1.0, v138
    v_mfma_f32_32x32x16_bf16 v[152:167], v[176:179], v[52:55], v[152:167]
    v_add_f32 v139, 1.0, v139
    v_add_f32 v140, 1.0, v140
    v_add_f32 v141, 1.0, v141
    v_add_f32 v142, 1.0, v142
    v_add_f32 v143, 1.0, v143
    v_add_f32 v144, 1.0, v144
    v_add_f32 v145, 1.0, v145
    v_add_f32 v146, 1.0, v146
    v_add_f32 v147, 1.0, v147
    v_add_f32 v148, 1.0, v148
    v_add_f32 v149, 1.0, v149
    v_add_f32 v150, 1.0, v150
    v_add_f32 v151, 1.0, v151
    v_mfma_f32_32x32x16_bf16 v[152:167], v[180:183], v[60:63], v[152:167]
    v_rcp_f32 v136, v136
    v_rcp_f32 v137, v137
    v_rcp_f32 v138, v138
    v_rcp_f32 v139, v139
    v_rcp_f32 v140, v140
    v_rcp_f32 v141, v141
    v_rcp_f32 v142, v142
    v_rcp_f32 v143, v143
    v_rcp_f32 v144, v144
    v_rcp_f32 v145, v145
    v_rcp_f32 v146, v146
    v_rcp_f32 v147, v147
    v_rcp_f32 v148, v148
    v_rcp_f32 v149, v149
    v_rcp_f32 v150, v150
    v_rcp_f32 v151, v151
    v_mul_f32 v152, v152, v136
    v_mul_f32 v153, v153, v137
    v_mul_f32 v154, v154, v138
    v_mul_f32 v155, v155, v139
    v_mul_f32 v156, v156, v140
    v_mul_f32 v157, v157, v141
    v_mul_f32 v158, v158, v142
    v_mul_f32 v159, v159, v143
    v_mul_f32 v160, v160, v144
    v_mul_f32 v161, v161, v145
    v_mul_f32 v162, v162, v146
    v_mul_f32 v163, v163, v147
    v_mul_f32 v164, v164, v148
    v_mul_f32 v165, v165, v149
    v_mul_f32 v166, v166, v150
    v_mul_f32 v167, v167, v151
    v_smfmac_f32_32x32x32_bf16 v[104:119], v[196:199], v[152:159], v204
    s_nop 0
    v_smfmac_f32_32x32x32_bf16 v[104:119], v[200:203], v[160:167], v204
    s_branch M_exit
M_half:
    s_setprio 1
    v_mfma_f32_32x32x16_bf16 v[136:151], v[184:187], v[68:71], 0
    v_exp_f32 v120, v120
    v_exp_f32 v121, v121
    v_smfmac_f32_32x32x32_bf16 v[104:119], v[196:199], v[152:159], v204
    v_exp_f32 v122, v122
    v_exp_f32 v123, v123
    v_smfmac_f32_32x32x32_bf16 v[104:119], v[200:203], v[160:167], v204
    ds_read_b64_tr_b16 v[196:197], v224
    ds_read_b64_tr_b16 v[198:199], v225
    v_exp_f32 v124, v124
    v_exp_f32 v125, v125
    v_mfma_f32_32x32x16_bf16 v[152:167], v[168:171], v[32:35], 0
    v_exp_f32 v126, v126
    v_exp_f32 v127, v127
    v_mfma_f32_32x32x16_bf16 v[152:167], v[172:175], v[40:43], v[152:167]
    v_add_f32 v120, 1.0, v120
    v_add_f32 v121, 1.0, v121
    v_add_f32 v122, 1.0, v122
    v_add_f32 v123, 1.0, v123
    v_mfma_f32_32x32x16_bf16 v[152:167], v[176:179], v[48:51], v[152:167]
    v_add_f32 v124, 1.0, v124
    v_add_f32 v125, 1.0, v125
    v_add_f32 v126, 1.0, v126
    v_add_f32 v127, 1.0, v127
    v_mfma_f32_32x32x16_bf16 v[152:167], v[180:183], v[56:59], v[152:167]
    v_rcp_f32 v120, v120
    v_rcp_f32 v121, v121
    v_smfmac_f32_32x32x32_bf16 v[136:151], v[188:191], v[80:87], v192
    v_rcp_f32 v122, v122
    v_rcp_f32 v123, v123
    v_mfma_f32_32x32x16_bf16 v[136:151], v[168:171], v[4:7], v[136:151]
    v_rcp_f32 v124, v124
    v_rcp_f32 v125, v125
    v_mfma_f32_32x32x16_bf16 v[136:151], v[172:175], v[12:15], v[136:151]
    v_rcp_f32 v126, v126
    v_rcp_f32 v127, v127
    v_mfma_f32_32x32x16_bf16 v[136:151], v[176:179], v[20:23], v[136:151]
    v_mul_f32 v152, v152, v120
    v_mul_f32 v153, v153, v121
    v_mul_f32 v154, v154, v122
    v_mul_f32 v155, v155, v123
    v_mfma_f32_32x32x16_bf16 v[136:151], v[180:183], v[28:31], v[136:151]
    v_mul_f32 v156, v156, v124
    v_mul_f32 v157, v157, v125
    v_mul_f32 v158, v158, v126
    v_mul_f32 v159, v159, v127
    s_waitcnt lgkmcnt(0)
    s_nop 0
    v_smfmac_f32_32x32x32_bf16 v[88:103], v[196:199], v[152:159], v204
    v_mfma_f32_32x32x16_bf16 v[152:167], v[168:171], v[36:39], 0
    s_nop 3
    v_exp_f32 v136, v136
    v_exp_f32 v137, v137
    v_exp_f32 v138, v138
    v_exp_f32 v139, v139
    v_mfma_f32_32x32x16_bf16 v[152:167], v[172:175], v[44:47], v[152:167]
    v_exp_f32 v140, v140
    v_exp_f32 v141, v141
    v_exp_f32 v142, v142
    v_exp_f32 v143, v143
    v_mfma_f32_32x32x16_bf16 v[152:167], v[176:179], v[52:55], v[152:167]
    v_add_f32 v136, 1.0, v136
    v_add_f32 v137, 1.0, v137
    v_add_f32 v138, 1.0, v138
    v_add_f32 v139, 1.0, v139
    v_add_f32 v140, 1.0, v140
    v_add_f32 v141, 1.0, v141
    v_add_f32 v142, 1.0, v142
    v_add_f32 v143, 1.0, v143
    v_mfma_f32_32x32x16_bf16 v[152:167], v[180:183], v[60:63], v[152:167]
    v_rcp_f32 v136, v136
    v_rcp_f32 v137, v137
    v_rcp_f32 v138, v138
    v_rcp_f32 v139, v139
    v_rcp_f32 v140, v140
    v_rcp_f32 v141, v141
    v_rcp_f32 v142, v142
    v_rcp_f32 v143, v143
    s_nop 3
    v_mul_f32 v152, v152, v136
    v_mul_f32 v153, v153, v137
    v_mul_f32 v154, v154, v138
    v_mul_f32 v155, v155, v139
    v_mul_f32 v156, v156, v140
    v_mul_f32 v157, v157, v141
    v_mul_f32 v158, v158, v142
    v_mul_f32 v159, v159, v143
    s_nop 1
    v_smfmac_f32_32x32x32_bf16 v[104:119], v[196:199], v[152:159], v204
    s_branch M_pq2
.p2align 12
M_pp2:
    s_branch M_pback
M_pq2:
M_exit:
    s_setprio 0
    s_cmp_eq_u32 s33, 0
    s_cbranch_scc1 M_epi
M_slow:
    s_waitcnt vmcnt(0) lgkmcnt(0)
    s_add_u32 s34, s34, 512
    s_cmp_ge_u32 s34, 800000
    s_cbranch_scc1 M_epi
M_batch:
    s_setprio 0
    s_load_dwordx4 s[44:47], s[0:1], 16
    s_nop 7
    s_nop 7
    s_barrier
    v_and_b32 v128, 63, v239
    v_lshrrev_b32 v129, 1, v128
    v_and_b32 v130, 3, v128
    v_and_or_b32 v129, v129, 28, v130
    v_and_b32 v130, 4, v128
    v_mul_u32_u24 v129, 1280, v129
    v_cmp_eq_u32 vcc, 0, v130
    v_add_u32 v129, 122112, v129
    v_lshlrev_b32 v128, 2, v128
    v_cndmask_b32 v129, 0, v129, vcc
    ds_write_b32 v128, v129 offset:5120
    v_add_u32 v153, s34, v239
    v_lshlrev_b32 v156, 2, v153
    s_waitcnt lgkmcnt(0)
    s_mov_b32 s60, s46
    s_mov_b32 s61, s47
    s_mov_b32 s62, 3200000
    s_mov_b32 s63, 0x20000
    s_mov_b32 s64, s44
    s_mov_b32 s65, s45
    s_mov_b32 s66, 3200000
    s_mov_b32 s67, 0x20000
    buffer_load_dword v154, v156, s[60:63], 0 offen
    buffer_load_dword v152, v156, s[64:67], 0 offen
    s_mov_b32 s46, 85599
    s_mov_b32 s48, 0
    s_mov_b32 s49, 536870912
    s_mov_b32 s50, 800000
    v_mov_b32 v158, -49
    v_mov_b32 v243, 8
    v_cmp_gt_u32 s[40:41], s50, v153
    s_waitcnt vmcnt(0)
    v_mul_u32_u24 v155, s46, v154
    v_lshrrev_b32 v155, 22, v155
    v_mad_i32_i24 v154, v155, v158, v154
    v_lshl_add_u32 v153, v155, 30, v153
    v_subrev_u32 v157, 25, v154
    v_and_or_b32 v153, v157, s49, v153
    v_min_u32 v154, v154, v157
    v_lshl_add_u32 v154, v154, 1, 14
    v_lshrrev_b32 v155, 2, v155
    v_cmp_eq_u32 vcc, s3, v155
    s_barrier
    s_and_b64 exec, vcc, s[40:41]
    v_lshrrev_b32 v120, 24, v153
    v_and_b32 v153, 0xfffff, v153
    v_lshl_or_b32 v153, v154, 24, v153
    ds_add_rtn_u32 v136, v120, v243 offset:5120
    s_waitcnt lgkmcnt(0)
    ds_write_b64 v136, v[152:153]
    s_mov_b64 exec, -1
    s_waitcnt lgkmcnt(0)
    s_barrier
    s_branch M_entry
M_slowinit:
    s_cmp_eq_u32 s33, 1
    s_cbranch_scc1 M_cont
    s_mov_b32 s33, 1
    s_mov_b32 s101, 0
    s_mov_b32 s34, 0
    v_mov_b32 v238, 1
    v_mov_b32 v120, 0
    s_cmp_eq_u32 s28, 1
    s_cbranch_scc0 M_batch
    s_mov_b64 exec, 1
    buffer_atomic_add v238, v120, s[4:7], 0 offen sc0 sc1
    s_mov_b64 exec, -1
    s_branch M_batch
M_epi:
    s_mov_b32 s10, 3216583135
    s_mov_b32 s8, 1065308039
    v_and_b32 v240, 31, v239
    v_lshlrev_b32 v240, 2, v240
    v_and_b32 v241, 32, v239
    v_lshl_add_u32 v240, v241, 4, v240
    v_readfirstlane_b32 s11, v238
    v_mov_b32 v242, 4
    v_mov_b32 v243, s38
    s_cmp_eq_u32 s11, 255
    s_cbranch_scc0 M_noep
    buffer_store_dword v243, v242, s[20:23], 0 offen
M_noep:
    s_lshl_b32 s11, s36, 7
    s_cmp_lt_u32 s28, 4
    s_cselect_b32 s40, -1, 0
    v_and_b32 v241, 0x7f, v240
    v_mul_f32 v121, s10, v89
    v_pk_mul_f32 v[122:123], v[90:91], s[10:11] op_sel_hi:[1,0]
    v_mul_f32 v125, s10, v93
    v_pk_mul_f32 v[126:127], v[94:95], s[10:11] op_sel_hi:[1,0]
    v_mul_f32 v129, s10, v97
    v_pk_mul_f32 v[130:131], v[98:99], s[10:11] op_sel_hi:[1,0]
    v_exp_f32 v121, v121
    v_exp_f32 v122, v122
    v_exp_f32 v123, v123
    v_exp_f32 v125, v125
    v_exp_f32 v126, v126
    v_exp_f32 v127, v127
    v_exp_f32 v129, v129
    v_exp_f32 v130, v130
    v_exp_f32 v131, v131
    v_fma_f32 v121, v121, s8, s8
    v_pk_fma_f32 v[122:123], v[122:123], s[8:9], s[8:9] op_sel_hi:[1,0,0]
    v_fma_f32 v125, v125, s8, s8
    v_pk_fma_f32 v[126:127], v[126:127], s[8:9], s[8:9] op_sel_hi:[1,0,0]
    v_fma_f32 v129, v129, s8, s8
    v_pk_fma_f32 v[130:131], v[130:131], s[8:9], s[8:9] op_sel_hi:[1,0,0]
    v_rcp_f32 v121, v121
    v_rcp_f32 v122, v122
    v_rcp_f32 v123, v123
    v_rcp_f32 v125, v125
    v_rcp_f32 v126, v126
    v_rcp_f32 v127, v127
    v_rcp_f32 v129, v129
    v_rcp_f32 v130, v130
    v_rcp_f32 v131, v131
    v_mul_f32 v89, v89, v121
    v_pk_mul_f32 v[90:91], v[90:91], v[122:123]
    v_mul_f32 v93, v93, v125
    v_pk_mul_f32 v[94:95], v[94:95], v[126:127]
    v_mul_f32 v97, v97, v129
    v_pk_mul_f32 v[98:99], v[98:99], v[130:131]
    v_mul_f32 v137, s10, v105
    v_pk_mul_f32 v[138:139], v[106:107], s[10:11] op_sel_hi:[1,0]
    v_mul_f32 v141, s10, v109
    v_exp_f32 v137, v137
    v_exp_f32 v138, v138
    v_exp_f32 v139, v139
    v_exp_f32 v141, v141
    v_fma_f32 v137, v137, s8, s8
    v_pk_fma_f32 v[138:139], v[138:139], s[8:9], s[8:9] op_sel_hi:[1,0,0]
    v_fma_f32 v141, v141, s8, s8
    v_rcp_f32 v137, v137
    v_rcp_f32 v138, v138
    v_rcp_f32 v139, v139
    v_rcp_f32 v141, v141
    v_mul_f32 v105, v105, v137
    v_pk_mul_f32 v[106:107], v[106:107], v[138:139]
    v_mul_f32 v109, v109, v141
    v_cvt_pk_bf16_f32 v153, v89, v105
    v_cvt_pk_bf16_f32 v154, v90, v106
    v_cvt_pk_bf16_f32 v155, v91, v107
    v_cvt_pk_bf16_f32 v157, v93, v109
    v_pk_mul_f32 v[142:143], v[110:111], s[10:11] op_sel_hi:[1,0]
    v_mul_f32 v145, s10, v113
    v_pk_mul_f32 v[146:147], v[114:115], s[10:11] op_sel_hi:[1,0]
    buffer_store_dword v153, v240, s[24:27], s11 offen offset:128 sc1
    v_exp_f32 v142, v142
    v_exp_f32 v143, v143
    v_exp_f32 v145, v145
    buffer_store_dword v154, v240, s[24:27], s11 offen offset:1152 sc1
    v_exp_f32 v146, v146
    v_exp_f32 v147, v147
    v_pk_fma_f32 v[142:143], v[142:143], s[8:9], s[8:9] op_sel_hi:[1,0,0]
    buffer_store_dword v155, v240, s[24:27], s11 offen offset:2176 sc1
    v_fma_f32 v145, v145, s8, s8
    v_pk_fma_f32 v[146:147], v[146:147], s[8:9], s[8:9] op_sel_hi:[1,0,0]
    v_rcp_f32 v142, v142
    buffer_store_dword v157, v240, s[24:27], s11 offen offset:384 sc1
    v_rcp_f32 v143, v143
    v_rcp_f32 v145, v145
    v_rcp_f32 v146, v146
    v_rcp_f32 v147, v147
    v_pk_mul_f32 v[110:111], v[110:111], v[142:143]
    v_mul_f32 v113, v113, v145
    v_pk_mul_f32 v[114:115], v[114:115], v[146:147]
    v_cvt_pk_bf16_f32 v158, v94, v110
    v_cvt_pk_bf16_f32 v159, v95, v111
    v_cvt_pk_bf16_f32 v161, v97, v113
    v_cvt_pk_bf16_f32 v162, v98, v114
    v_cvt_pk_bf16_f32 v163, v99, v115
    v_pk_mul_f32 v[132:133], v[100:101], s[10:11] op_sel_hi:[1,0]
    v_pk_mul_f32 v[134:135], v[102:103], s[10:11] op_sel_hi:[1,0]
    v_pk_mul_f32 v[148:149], v[116:117], s[10:11] op_sel_hi:[1,0]
    buffer_store_dword v158, v240, s[24:27], s11 offen offset:1408 sc1
    v_pk_mul_f32 v[150:151], v[118:119], s[10:11] op_sel_hi:[1,0]
    v_exp_f32 v132, v132
    v_exp_f32 v133, v133
    buffer_store_dword v159, v240, s[24:27], s11 offen offset:2432 sc1
    v_exp_f32 v134, v134
    v_exp_f32 v135, v135
    v_exp_f32 v148, v148
    buffer_store_dword v161, v240, s[24:27], s11 offen offset:256 sc1
    v_exp_f32 v149, v149
    v_exp_f32 v150, v150
    v_exp_f32 v151, v151
    buffer_store_dword v162, v240, s[24:27], s11 offen offset:1280 sc1
    v_pk_fma_f32 v[132:133], v[132:133], s[8:9], s[8:9] op_sel_hi:[1,0,0]
    v_pk_fma_f32 v[134:135], v[134:135], s[8:9], s[8:9] op_sel_hi:[1,0,0]
    v_pk_fma_f32 v[148:149], v[148:149], s[8:9], s[8:9] op_sel_hi:[1,0,0]
    buffer_store_dword v163, v240, s[24:27], s11 offen offset:2304 sc1
    v_pk_fma_f32 v[150:151], v[150:151], s[8:9], s[8:9] op_sel_hi:[1,0,0]
    v_rcp_f32 v132, v132
    v_rcp_f32 v133, v133
    v_rcp_f32 v134, v134
    v_rcp_f32 v135, v135
    v_rcp_f32 v148, v148
    v_rcp_f32 v149, v149
    v_rcp_f32 v150, v150
    v_rcp_f32 v151, v151
    v_pk_mul_f32 v[100:101], v[100:101], v[132:133]
    v_pk_mul_f32 v[102:103], v[102:103], v[134:135]
    v_pk_mul_f32 v[116:117], v[116:117], v[148:149]
    v_pk_mul_f32 v[118:119], v[118:119], v[150:151]
    v_cvt_pk_bf16_f32 v164, v100, v116
    v_cvt_pk_bf16_f32 v165, v101, v117
    v_cvt_pk_bf16_f32 v166, v102, v118
    v_cvt_pk_bf16_f32 v167, v103, v119
    buffer_store_dword v165, v240, s[24:27], s11 offen offset:512 sc1
    buffer_store_dword v166, v240, s[24:27], s11 offen offset:1536 sc1
    s_mov_b32 exec_hi, s40
    buffer_store_dword v167, v240, s[24:27], s11 offen offset:2560 sc1
    s_mov_b32 exec_hi, -1
    s_mov_b32 exec_lo, 0
    buffer_store_dword v164, v241, s[24:27], s11 offen sc1
M_end2:
M_end:
    s_endpgm
M_loopb:
    s_setprio 2
    v_mfma_f32_32x32x16_bf16 v[136:151], v[184:187], v[68:71], 0
    ds_read_u8 v222, v236 offset:256
    v_exp_f32 v120, v120
    v_exp_f32 v121, v121
    v_exp_f32 v122, v122
    v_smfmac_f32_32x32x32_bf16 v[104:119], v[196:199], v[152:159], v204
    v_exp_f32 v123, v123
    v_exp_f32 v124, v124
    v_exp_f32 v125, v125
    v_smfmac_f32_32x32x32_bf16 v[104:119], v[200:203], v[160:167], v204
    ds_read_b64_tr_b16 v[196:197], v224
    ds_read_b64_tr_b16 v[198:199], v225
    ds_read_b64_tr_b16 v[200:201], v226
    ds_read_b64_tr_b16 v[202:203], v227
    v_exp_f32 v126, v126
    v_exp_f32 v127, v127
    v_exp_f32 v128, v128
    v_mfma_f32_32x32x16_bf16 v[152:167], v[168:171], v[32:35], 0
    v_exp_f32 v129, v129
    v_exp_f32 v130, v130
    v_exp_f32 v131, v131
    v_mfma_f32_32x32x16_bf16 v[152:167], v[172:175], v[40:43], v[152:167]
    v_exp_f32 v132, v132
    v_exp_f32 v133, v133
    v_mfma_f32_32x32x16_bf16 v[152:167], v[176:179], v[48:51], v[152:167]
    v_exp_f32 v134, v134
    v_exp_f32 v135, v135
    v_mfma_f32_32x32x16_bf16 v[152:167], v[180:183], v[56:59], v[152:167]
    s_setprio 1
    v_add_f32 v120, 1.0, v120
    v_add_f32 v121, 1.0, v121
    v_add_f32 v122, 1.0, v122
    v_add_f32 v123, 1.0, v123
    v_add_f32 v124, 1.0, v124
    v_add_f32 v125, 1.0, v125
    v_add_f32 v126, 1.0, v126
    v_add_f32 v127, 1.0, v127
    v_add_f32 v128, 1.0, v128
    v_add_f32 v129, 1.0, v129
    v_add_f32 v130, 1.0, v130
    v_add_f32 v131, 1.0, v131
    v_add_f32 v132, 1.0, v132
    v_add_f32 v133, 1.0, v133
    v_add_f32 v134, 1.0, v134
    v_add_f32 v135, 1.0, v135
    s_waitcnt lgkmcnt(4)
    s_setprio 2
    v_smfmac_f32_32x32x32_bf16 v[136:151], v[188:191], v[80:87], v192
    s_waitcnt vmcnt(4)
    ds_read_b128 v[184:187], v233 offset:1024
    ds_read_b64 v[246:247], v235 offset:512
    ds_read_u16 v212, v234 offset:512
    ds_read_u16 v214, v234 offset:576
    ds_read_u16 v216, v234 offset:640
    ds_read_u16 v218, v234 offset:704
    v_rcp_f32 v120, v120
    v_rcp_f32 v121, v121
    v_rcp_f32 v122, v122
    v_mfma_f32_32x32x16_bf16 v[136:151], v[168:171], v[4:7], v[136:151]
    v_rcp_f32 v123, v123
    v_rcp_f32 v124, v124
    v_rcp_f32 v125, v125
    v_mfma_f32_32x32x16_bf16 v[136:151], v[172:175], v[12:15], v[136:151]
    v_rcp_f32 v126, v126
    v_rcp_f32 v127, v127
    v_rcp_f32 v128, v128
    v_mfma_f32_32x32x16_bf16 v[136:151], v[176:179], v[20:23], v[136:151]
    v_rcp_f32 v129, v129
    v_rcp_f32 v130, v130
    v_rcp_f32 v131, v131
    v_mfma_f32_32x32x16_bf16 v[136:151], v[180:183], v[28:31], v[136:151]
    v_rcp_f32 v132, v132
    v_rcp_f32 v133, v133
    v_rcp_f32 v134, v134
    v_rcp_f32 v135, v135
    s_setprio 1
    v_lshrrev_b32 v192, 4, v222
    v_lshlrev_b16 v192, v222, v192
    v_mul_f32 v152, v152, v120
    v_mul_f32 v153, v153, v121
    v_mul_f32 v154, v154, v122
    v_mul_f32 v155, v155, v123
    v_mul_f32 v156, v156, v124
    v_mul_f32 v157, v157, v125
    v_mul_f32 v158, v158, v126
    v_mul_f32 v159, v159, v127
    v_mul_f32 v160, v160, v128
    v_mul_f32 v161, v161, v129
    v_mul_f32 v162, v162, v130
    v_mul_f32 v163, v163, v131
    v_mul_f32 v164, v164, v132
    v_mul_f32 v165, v165, v133
    v_mul_f32 v166, v166, v134
    v_mul_f32 v167, v167, v135
    s_waitcnt lgkmcnt(4)
    v_bfe_u32 v220, v246, 16, 12
    v_mad_u32_u24 v220, v247, 1, v220
    s_setprio 2
    v_mfma_f32_32x32x16_bf16 v[120:135], v[184:187], v[64:67], 0
    ds_read_u8 v224, v237 offset:256
    ds_read_u8 v225, v237 offset:288
    ds_read_u8 v226, v237 offset:384
    ds_read_u8 v227, v237 offset:416
    v_exp_f32 v136, v136
    v_exp_f32 v137, v137
    v_exp_f32 v138, v138
    v_smfmac_f32_32x32x32_bf16 v[88:103], v[196:199], v[152:159], v204
    v_exp_f32 v139, v139
    v_exp_f32 v140, v140
    v_exp_f32 v141, v141
    v_smfmac_f32_32x32x32_bf16 v[88:103], v[200:203], v[160:167], v204
    v_exp_f32 v142, v142
    v_exp_f32 v143, v143
    v_exp_f32 v144, v144
    s_waitcnt vmcnt(0)
    v_mfma_f32_32x32x16_bf16 v[152:167], v[168:171], v[36:39], 0
    ds_read_b128 v[168:171], v229 offset:32768
    v_exp_f32 v145, v145
    v_exp_f32 v146, v146
    v_exp_f32 v147, v147
    v_mfma_f32_32x32x16_bf16 v[152:167], v[172:175], v[44:47], v[152:167]
    ds_read_b128 v[172:175], v230 offset:32768
    v_exp_f32 v148, v148
    v_exp_f32 v149, v149
    v_mfma_f32_32x32x16_bf16 v[152:167], v[176:179], v[52:55], v[152:167]
    ds_read_b128 v[176:179], v231 offset:32768
    v_exp_f32 v150, v150
    v_exp_f32 v151, v151
    v_mfma_f32_32x32x16_bf16 v[152:167], v[180:183], v[60:63], v[152:167]
    ds_read_b128 v[180:183], v232 offset:32768
    s_setprio 1
    v_add_f32 v136, 1.0, v136
    v_add_f32 v137, 1.0, v137
    v_add_f32 v138, 1.0, v138
    v_add_f32 v139, 1.0, v139
    v_add_f32 v140, 1.0, v140
    v_add_f32 v141, 1.0, v141
    v_add_f32 v142, 1.0, v142
    v_add_f32 v143, 1.0, v143
    v_add_f32 v144, 1.0, v144
    v_add_f32 v145, 1.0, v145
    v_add_f32 v146, 1.0, v146
    v_add_f32 v147, 1.0, v147
    v_add_f32 v148, 1.0, v148
    v_add_f32 v149, 1.0, v149
    v_add_f32 v150, 1.0, v150
    v_add_f32 v151, 1.0, v151
    s_setprio 2
    v_smfmac_f32_32x32x32_bf16 v[120:135], v[188:191], v[72:79], v192
    v_rcp_f32 v136, v136
    v_rcp_f32 v137, v137
    v_rcp_f32 v138, v138
    s_waitcnt lgkmcnt(3)
    v_mfma_f32_32x32x16_bf16 v[120:135], v[168:171], v[0:3], v[120:135]
    v_rcp_f32 v139, v139
    v_rcp_f32 v140, v140
    v_rcp_f32 v141, v141
    s_waitcnt lgkmcnt(2)
    v_mfma_f32_32x32x16_bf16 v[120:135], v[172:175], v[8:11], v[120:135]
    v_rcp_f32 v142, v142
    v_rcp_f32 v143, v143
    v_rcp_f32 v144, v144
    s_waitcnt lgkmcnt(1)
    v_mfma_f32_32x32x16_bf16 v[120:135], v[176:179], v[16:19], v[120:135]
    v_rcp_f32 v145, v145
    v_rcp_f32 v146, v146
    v_rcp_f32 v147, v147
    s_waitcnt lgkmcnt(0)
    v_mfma_f32_32x32x16_bf16 v[120:135], v[180:183], v[24:27], v[120:135]
    s_add_u32 m0, s32, 0
    v_rcp_f32 v148, v148
    buffer_load_dwordx4 v[220:221], s[16:19], 0 idxen offen  lds
    s_add_u32 m0, s31, 0
    v_rcp_f32 v149, v149
    buffer_load_dwordx4 v[212:213], s[12:15], 0 idxen offen lds
    s_add_u32 m0, s31, 1024
    v_rcp_f32 v150, v150
    buffer_load_dwordx4 v[214:215], s[12:15], 0 idxen offen lds
    s_add_u32 m0, s31, 2048
    v_rcp_f32 v151, v151
    buffer_load_dwordx4 v[216:217], s[12:15], 0 idxen offen lds
    s_add_u32 m0, s31, 3072
    s_nop 0
    buffer_load_dwordx4 v[218:219], s[12:15], 0 idxen offen lds
    s_setprio 1
    v_mad_u32_u24 v224, v224, s75, v228
    v_mad_u32_u24 v225, v225, s75, v228
    v_mad_u32_u24 v226, v226, s75, v228
    v_mad_u32_u24 v227, v227, s75, v228
    v_mul_f32 v152, v152, v136
    v_mul_f32 v153, v153, v137
    v_mul_f32 v154, v154, v138
    v_mul_f32 v155, v155, v139
    v_mul_f32 v156, v156, v140
    v_mul_f32 v157, v157, v141
    v_mul_f32 v158, v158, v142
    v_mul_f32 v159, v159, v143
    v_mul_f32 v160, v160, v144
    v_mul_f32 v161, v161, v145
    v_mul_f32 v162, v162, v146
    v_mul_f32 v163, v163, v147
    v_mul_f32 v164, v164, v148
    v_mul_f32 v165, v165, v149
    v_mul_f32 v166, v166, v150
    v_mul_f32 v167, v167, v151
    s_sub_u32 s30, s30, 1
    s_cmp_eq_u32 s30, 0
    s_cbranch_scc1 M_drain
    s_setprio 2
    v_mfma_f32_32x32x16_bf16 v[136:151], v[184:187], v[68:71], 0
    ds_read_u8 v222, v236 offset:512
    v_exp_f32 v120, v120
    v_exp_f32 v121, v121
    v_exp_f32 v122, v122
    v_smfmac_f32_32x32x32_bf16 v[104:119], v[196:199], v[152:159], v204
    v_exp_f32 v123, v123
    v_exp_f32 v124, v124
    v_exp_f32 v125, v125
    v_smfmac_f32_32x32x32_bf16 v[104:119], v[200:203], v[160:167], v204
    ds_read_b64_tr_b16 v[196:197], v224
    ds_read_b64_tr_b16 v[198:199], v225
    ds_read_b64_tr_b16 v[200:201], v226
    ds_read_b64_tr_b16 v[202:203], v227
    v_exp_f32 v126, v126
    v_exp_f32 v127, v127
    v_exp_f32 v128, v128
    v_mfma_f32_32x32x16_bf16 v[152:167], v[168:171], v[32:35], 0
    v_exp_f32 v129, v129
    v_exp_f32 v130, v130
    v_exp_f32 v131, v131
    v_mfma_f32_32x32x16_bf16 v[152:167], v[172:175], v[40:43], v[152:167]
    v_exp_f32 v132, v132
    v_exp_f32 v133, v133
    v_mfma_f32_32x32x16_bf16 v[152:167], v[176:179], v[48:51], v[152:167]
    v_exp_f32 v134, v134
    v_exp_f32 v135, v135
    v_mfma_f32_32x32x16_bf16 v[152:167], v[180:183], v[56:59], v[152:167]
    s_setprio 1
    v_add_f32 v120, 1.0, v120
    v_add_f32 v121, 1.0, v121
    v_add_f32 v122, 1.0, v122
    v_add_f32 v123, 1.0, v123
    v_add_f32 v124, 1.0, v124
    v_add_f32 v125, 1.0, v125
    v_add_f32 v126, 1.0, v126
    v_add_f32 v127, 1.0, v127
    v_add_f32 v128, 1.0, v128
    v_add_f32 v129, 1.0, v129
    v_add_f32 v130, 1.0, v130
    v_add_f32 v131, 1.0, v131
    v_add_f32 v132, 1.0, v132
    v_add_f32 v133, 1.0, v133
    v_add_f32 v134, 1.0, v134
    v_add_f32 v135, 1.0, v135
    s_waitcnt lgkmcnt(4)
    s_setprio 2
    v_smfmac_f32_32x32x32_bf16 v[136:151], v[188:191], v[80:87], v192
    s_waitcnt vmcnt(4)
    ds_read_b128 v[184:187], v233 offset:0
    ds_read_b64 v[246:247], v235 offset:768
    ds_read_u16 v212, v234 offset:768
    ds_read_u16 v214, v234 offset:832
    ds_read_u16 v216, v234 offset:896
    ds_read_u16 v218, v234 offset:960
    v_rcp_f32 v120, v120
    v_rcp_f32 v121, v121
    v_rcp_f32 v122, v122
    v_mfma_f32_32x32x16_bf16 v[136:151], v[168:171], v[4:7], v[136:151]
    v_rcp_f32 v123, v123
    v_rcp_f32 v124, v124
    v_rcp_f32 v125, v125
    v_mfma_f32_32x32x16_bf16 v[136:151], v[172:175], v[12:15], v[136:151]
    v_rcp_f32 v126, v126
    v_rcp_f32 v127, v127
    v_rcp_f32 v128, v128
    v_mfma_f32_32x32x16_bf16 v[136:151], v[176:179], v[20:23], v[136:151]
    v_rcp_f32 v129, v129
    v_rcp_f32 v130, v130
    v_rcp_f32 v131, v131
    v_mfma_f32_32x32x16_bf16 v[136:151], v[180:183], v[28:31], v[136:151]
    v_rcp_f32 v132, v132
    v_rcp_f32 v133, v133
    v_rcp_f32 v134, v134
    v_rcp_f32 v135, v135
    s_setprio 1
    v_lshrrev_b32 v192, 4, v222
    v_lshlrev_b16 v192, v222, v192
    v_mul_f32 v152, v152, v120
    v_mul_f32 v153, v153, v121
    v_mul_f32 v154, v154, v122
    v_mul_f32 v155, v155, v123
    v_mul_f32 v156, v156, v124
    v_mul_f32 v157, v157, v125
    v_mul_f32 v158, v158, v126
    v_mul_f32 v159, v159, v127
    v_mul_f32 v160, v160, v128
    v_mul_f32 v161, v161, v129
    v_mul_f32 v162, v162, v130
    v_mul_f32 v163, v163, v131
    v_mul_f32 v164, v164, v132
    v_mul_f32 v165, v165, v133
    v_mul_f32 v166, v166, v134
    v_mul_f32 v167, v167, v135
    s_waitcnt lgkmcnt(4)
    v_bfe_u32 v220, v246, 16, 12
    v_mad_u32_u24 v220, v247, 1, v220
    s_setprio 2
    v_mfma_f32_32x32x16_bf16 v[120:135], v[184:187], v[64:67], 0
    ds_read_u8 v224, v237 offset:512
    ds_read_u8 v225, v237 offset:544
    ds_read_u8 v226, v237 offset:640
    ds_read_u8 v227, v237 offset:672
    v_exp_f32 v136, v136
    v_exp_f32 v137, v137
    v_exp_f32 v138, v138
    v_smfmac_f32_32x32x32_bf16 v[88:103], v[196:199], v[152:159], v204
    v_exp_f32 v139, v139
    v_exp_f32 v140, v140
    v_exp_f32 v141, v141
    v_smfmac_f32_32x32x32_bf16 v[88:103], v[200:203], v[160:167], v204
    v_exp_f32 v142, v142
    v_exp_f32 v143, v143
    v_exp_f32 v144, v144
    s_waitcnt vmcnt(0)
    v_mfma_f32_32x32x16_bf16 v[152:167], v[168:171], v[36:39], 0
    ds_read_b128 v[168:171], v229 offset:0
    v_exp_f32 v145, v145
    v_exp_f32 v146, v146
    v_exp_f32 v147, v147
    v_mfma_f32_32x32x16_bf16 v[152:167], v[172:175], v[44:47], v[152:167]
    ds_read_b128 v[172:175], v230 offset:0
    v_exp_f32 v148, v148
    v_exp_f32 v149, v149
    v_mfma_f32_32x32x16_bf16 v[152:167], v[176:179], v[52:55], v[152:167]
    ds_read_b128 v[176:179], v231 offset:0
    v_exp_f32 v150, v150
    v_exp_f32 v151, v151
    v_mfma_f32_32x32x16_bf16 v[152:167], v[180:183], v[60:63], v[152:167]
    ds_read_b128 v[180:183], v232 offset:0
    s_setprio 1
    v_add_f32 v136, 1.0, v136
    v_add_f32 v137, 1.0, v137
    v_add_f32 v138, 1.0, v138
    v_add_f32 v139, 1.0, v139
    v_add_f32 v140, 1.0, v140
    v_add_f32 v141, 1.0, v141
    v_add_f32 v142, 1.0, v142
    v_add_f32 v143, 1.0, v143
    v_add_f32 v144, 1.0, v144
    v_add_f32 v145, 1.0, v145
    v_add_f32 v146, 1.0, v146
    v_add_f32 v147, 1.0, v147
    v_add_f32 v148, 1.0, v148
    v_add_f32 v149, 1.0, v149
    v_add_f32 v150, 1.0, v150
    v_add_f32 v151, 1.0, v151
    s_setprio 2
    v_smfmac_f32_32x32x32_bf16 v[120:135], v[188:191], v[72:79], v192
    v_rcp_f32 v136, v136
    v_rcp_f32 v137, v137
    v_rcp_f32 v138, v138
    s_waitcnt lgkmcnt(3)
    v_mfma_f32_32x32x16_bf16 v[120:135], v[168:171], v[0:3], v[120:135]
    v_rcp_f32 v139, v139
    v_rcp_f32 v140, v140
    v_rcp_f32 v141, v141
    s_waitcnt lgkmcnt(2)
    v_mfma_f32_32x32x16_bf16 v[120:135], v[172:175], v[8:11], v[120:135]
    v_rcp_f32 v142, v142
    v_rcp_f32 v143, v143
    v_rcp_f32 v144, v144
    s_waitcnt lgkmcnt(1)
    v_mfma_f32_32x32x16_bf16 v[120:135], v[176:179], v[16:19], v[120:135]
    v_rcp_f32 v145, v145
    v_rcp_f32 v146, v146
    v_rcp_f32 v147, v147
    s_waitcnt lgkmcnt(0)
    v_mfma_f32_32x32x16_bf16 v[120:135], v[180:183], v[24:27], v[120:135]
    s_add_u32 m0, s32, 1024
    v_rcp_f32 v148, v148
    buffer_load_dwordx4 v[220:221], s[16:19], 0 idxen offen  lds
    s_add_u32 m0, s31, 32768
    v_rcp_f32 v149, v149
    buffer_load_dwordx4 v[212:213], s[12:15], 0 idxen offen lds
    s_add_u32 m0, s31, 33792
    v_rcp_f32 v150, v150
    buffer_load_dwordx4 v[214:215], s[12:15], 0 idxen offen lds
    s_add_u32 m0, s31, 34816
    v_rcp_f32 v151, v151
    buffer_load_dwordx4 v[216:217], s[12:15], 0 idxen offen lds
    s_add_u32 m0, s31, 35840
    s_nop 0
    buffer_load_dwordx4 v[218:219], s[12:15], 0 idxen offen lds
    s_setprio 1
    v_mad_u32_u24 v224, v224, s75, v228
    v_mad_u32_u24 v225, v225, s75, v228
    v_mad_u32_u24 v226, v226, s75, v228
    v_mad_u32_u24 v227, v227, s75, v228
    v_add_u32 v234, 512, v234
    v_add_u32 v235, 512, v235
    v_add_u32 v236, 512, v236
    v_add_u32 v237, 512, v237
    v_mul_f32 v152, v152, v136
    v_mul_f32 v153, v153, v137
    v_mul_f32 v154, v154, v138
    v_mul_f32 v155, v155, v139
    v_mul_f32 v156, v156, v140
    v_mul_f32 v157, v157, v141
    v_mul_f32 v158, v158, v142
    v_mul_f32 v159, v159, v143
    v_mul_f32 v160, v160, v144
    v_mul_f32 v161, v161, v145
    v_mul_f32 v162, v162, v146
    v_mul_f32 v163, v163, v147
    v_mul_f32 v164, v164, v148
    v_mul_f32 v165, v165, v149
    v_mul_f32 v166, v166, v150
    v_mul_f32 v167, v167, v151
    s_sub_u32 s30, s30, 1
    s_cmp_lg_u32 s30, 0
    s_cbranch_scc1 M_loopb
    s_branch M_drain
.p2align 12
M_hop_r:
    s_branch M_pback
M_flag:
    s_mov_b32 exec_lo, 0x80808080
    s_mov_b32 exec_hi, 0x80808080
    v_bfrev_b32 v125, 1
    s_waitcnt lgkmcnt(0)
    v_cmp_le_u32 s[10:11], s51, v120
    s_nop 1
    v_cndmask_b32 v126, 0, v125, s[10:11]
    v_or_b32 v91, v126, v91
    v_cmp_le_u32 s[10:11], s51, v121
    s_nop 1
    v_cndmask_b32 v126, 0, v125, s[10:11]
    v_or_b32 v95, v126, v95
    v_cmp_le_u32 s[10:11], s51, v122
    s_nop 1
    v_cndmask_b32 v126, 0, v125, s[10:11]
    v_or_b32 v99, v126, v99
    v_cmp_le_u32 s[10:11], s51, v123
    s_nop 1
    v_cndmask_b32 v126, 0, v125, s[10:11]
    v_or_b32 v103, v126, v103
    s_mov_b64 exec, -1
    s_branch M_flagged
M_repoll:
    v_mov_b32 v101, s73
    s_mov_b32 exec_lo, 0x80808080
    s_mov_b32 exec_hi, 0x80808080
    v_and_b32 v101, 0x7fffffff, v101
    s_mov_b64 exec, -1
    v_and_b32 v100, v101, v100
    v_cmp_ne_u32 vcc, 0, v100
    s_cbranch_vccz M_more
    v_and_b32 v100, v101, v96
    v_cmp_ne_u32 vcc, 0, v100
    s_cbranch_vccz M_rp0
    buffer_load_dwordx4 v[152:155], v244, s[20:23], s64 offen sc1
M_rp0:
    v_and_b32 v100, v101, v97
    v_cmp_ne_u32 vcc, 0, v100
    s_cbranch_vccz M_rp1
    buffer_load_dwordx4 v[156:159], v244, s[20:23], s65 offen sc1
M_rp1:
    v_and_b32 v100, v101, v98
    v_cmp_ne_u32 vcc, 0, v100
    s_cbranch_vccz M_rp2
    buffer_load_dwordx4 v[160:163], v244, s[20:23], s66 offen sc1
M_rp2:
    v_and_b32 v100, v101, v99
    v_cmp_ne_u32 vcc, 0, v100
    s_cbranch_vccz M_rp3
    buffer_load_dwordx4 v[164:167], v244, s[20:23], s67 offen sc1
M_rp3:
    s_add_u32 s35, s35, 1
    s_cmp_lt_u32 s35, 4000
    s_cbranch_scc1 M_poll
M_giveup:
    s_mov_b64 exec, -1
    s_waitcnt vmcnt(0)
    v_mov_b32 v120, 0
    ds_write_b32 v120, v243 offset:5136
    s_branch M_routed
M_more:
    v_cmp_gt_i32 s[10:11], 0, v96
    s_add_u32 s64, s64, 8388608
    s_lshr_b64 s[10:11], s[10:11], 7
    s_mul_i32 s40, s10, 0xff
    s_mul_i32 s41, s11, 0xff
    s_mov_b64 exec, s[40:41]
    s_cbranch_execz M_mo0
    buffer_load_dwordx4 v[120:123], v244, s[20:23], s64 offen sc1
M_mo0:
    s_mov_b64 exec, -1
    v_cmp_gt_i32 s[10:11], 0, v97
    s_add_u32 s65, s65, 8388608
    s_lshr_b64 s[10:11], s[10:11], 7
    s_mul_i32 s42, s10, 0xff
    s_mul_i32 s43, s11, 0xff
    s_mov_b64 exec, s[42:43]
    s_cbranch_execz M_mo1
    buffer_load_dwordx4 v[124:127], v244, s[20:23], s65 offen sc1
M_mo1:
    s_mov_b64 exec, -1
    v_cmp_gt_i32 s[10:11], 0, v98
    s_add_u32 s66, s66, 8388608
    s_lshr_b64 s[10:11], s[10:11], 7
    s_mul_i32 s44, s10, 0xff
    s_mul_i32 s45, s11, 0xff
    s_mov_b64 exec, s[44:45]
    s_cbranch_execz M_mo2
    buffer_load_dwordx4 v[128:131], v244, s[20:23], s66 offen sc1
M_mo2:
    s_mov_b64 exec, -1
    v_cmp_gt_i32 s[10:11], 0, v99
    s_add_u32 s67, s67, 8388608
    s_lshr_b64 s[10:11], s[10:11], 7
    s_mul_i32 s46, s10, 0xff
    s_mul_i32 s47, s11, 0xff
    s_mov_b64 exec, s[46:47]
    s_cbranch_execz M_mo3
    buffer_load_dwordx4 v[132:135], v244, s[20:23], s67 offen sc1
M_mo3:
    s_mov_b64 exec, -1
    s_branch M_route
M_second:
    s_waitcnt vmcnt(0) lgkmcnt(0)
    s_mov_b64 exec, s[40:41]
    s_cbranch_execz M_se0
    v_xor_b32 v96, s72, v123
    v_and_b32 v97, s73, v96
    v_cmp_ne_u32 vcc, 0, v97
    s_cbranch_vccz M_sg0
    buffer_load_dwordx4 v[120:123], v244, s[20:23], s64 offen sc1
    s_add_u32 s35, s35, 1
    s_cmp_lt_u32 s35, 4000
    s_cbranch_scc1 M_second
    s_branch M_giveup
M_sg0:
    v_lshl_add_u32 v96, v96, 1, v95
    v_and_b32 v136, s39, v120
    v_cmpx_ne_u16 s[48:49], -1, v120
    v_lshrrev_b32_sdwa v184, v136, s96 dst_sel:DWORD dst_unused:UNUSED_PAD src0_sel:BYTE_1 src1_sel:DWORD
    v_or_b32_sdwa v136, v136, v184 dst_sel:DWORD dst_unused:UNUSED_PAD src0_sel:BYTE_3 src1_sel:BYTE_0
    v_perm_b32 v184, v96, v88, v92
    ds_add_rtn_u32 v136, v136, v243 offset:5120
    v_and_b32 v137, s39, v121
    v_cmpx_ne_u16 s[50:51], -1, v121
    v_lshrrev_b32_sdwa v185, v137, s96 dst_sel:DWORD dst_unused:UNUSED_PAD src0_sel:BYTE_1 src1_sel:DWORD
    v_or_b32_sdwa v137, v137, v185 dst_sel:DWORD dst_unused:UNUSED_PAD src0_sel:BYTE_3 src1_sel:BYTE_0
    v_perm_b32 v185, v96, v88, v93
    ds_add_rtn_u32 v137, v137, v243 offset:5120
    v_and_b32 v138, s39, v122
    v_cmpx_ne_u16 s[52:53], -1, v122
    v_lshrrev_b32_sdwa v186, v138, s96 dst_sel:DWORD dst_unused:UNUSED_PAD src0_sel:BYTE_1 src1_sel:DWORD
    v_or_b32_sdwa v138, v138, v186 dst_sel:DWORD dst_unused:UNUSED_PAD src0_sel:BYTE_3 src1_sel:BYTE_0
    v_perm_b32 v186, v96, v88, v94
    ds_add_rtn_u32 v138, v138, v243 offset:5120
    s_mov_b64 s[40:41], 0
    s_or_b32 s10, s52, s53
    s_waitcnt lgkmcnt(0)
    s_mov_b64 exec, s[48:49]
    ds_write2_b32 v136, v120, v184 offset1:1
    s_mov_b64 exec, s[50:51]
    ds_write2_b32 v137, v121, v185 offset1:1
    s_mov_b64 exec, s[52:53]
    ds_write2_b32 v138, v122, v186 offset1:1
    s_and_b32 s10, s10, 0x80808080
    s_waitcnt lgkmcnt(0)
    s_cbranch_scc1 M_giveup
M_se0:
    s_mov_b64 exec, s[42:43]
    s_cbranch_execz M_se1
    v_xor_b32 v96, s72, v127
    v_and_b32 v97, s73, v96
    v_cmp_ne_u32 vcc, 0, v97
    s_cbranch_vccz M_sg1
    buffer_load_dwordx4 v[124:127], v244, s[20:23], s65 offen sc1
    s_add_u32 s35, s35, 1
    s_cmp_lt_u32 s35, 4000
    s_cbranch_scc1 M_second
    s_branch M_giveup
M_sg1:
    v_lshl_add_u32 v96, v96, 1, v95
    v_and_b32 v136, s39, v124
    v_cmpx_ne_u16 s[48:49], -1, v124
    v_lshrrev_b32_sdwa v184, v136, s96 dst_sel:DWORD dst_unused:UNUSED_PAD src0_sel:BYTE_1 src1_sel:DWORD
    v_or_b32_sdwa v136, v136, v184 dst_sel:DWORD dst_unused:UNUSED_PAD src0_sel:BYTE_3 src1_sel:BYTE_0
    v_perm_b32 v184, v96, v89, v92
    ds_add_rtn_u32 v136, v136, v243 offset:5120
    v_and_b32 v137, s39, v125
    v_cmpx_ne_u16 s[50:51], -1, v125
    v_lshrrev_b32_sdwa v185, v137, s96 dst_sel:DWORD dst_unused:UNUSED_PAD src0_sel:BYTE_1 src1_sel:DWORD
    v_or_b32_sdwa v137, v137, v185 dst_sel:DWORD dst_unused:UNUSED_PAD src0_sel:BYTE_3 src1_sel:BYTE_0
    v_perm_b32 v185, v96, v89, v93
    ds_add_rtn_u32 v137, v137, v243 offset:5120
    v_and_b32 v138, s39, v126
    v_cmpx_ne_u16 s[52:53], -1, v126
    v_lshrrev_b32_sdwa v186, v138, s96 dst_sel:DWORD dst_unused:UNUSED_PAD src0_sel:BYTE_1 src1_sel:DWORD
    v_or_b32_sdwa v138, v138, v186 dst_sel:DWORD dst_unused:UNUSED_PAD src0_sel:BYTE_3 src1_sel:BYTE_0
    v_perm_b32 v186, v96, v89, v94
    ds_add_rtn_u32 v138, v138, v243 offset:5120
    s_mov_b64 s[42:43], 0
    s_or_b32 s10, s52, s53
    s_waitcnt lgkmcnt(0)
    s_mov_b64 exec, s[48:49]
    ds_write2_b32 v136, v124, v184 offset1:1
    s_mov_b64 exec, s[50:51]
    ds_write2_b32 v137, v125, v185 offset1:1
    s_mov_b64 exec, s[52:53]
    ds_write2_b32 v138, v126, v186 offset1:1
    s_and_b32 s10, s10, 0x80808080
    s_waitcnt lgkmcnt(0)
    s_cbranch_scc1 M_giveup
M_se1:
    s_mov_b64 exec, s[44:45]
    s_cbranch_execz M_se2
    v_xor_b32 v96, s72, v131
    v_and_b32 v97, s73, v96
    v_cmp_ne_u32 vcc, 0, v97
    s_cbranch_vccz M_sg2
    buffer_load_dwordx4 v[128:131], v244, s[20:23], s66 offen sc1
    s_add_u32 s35, s35, 1
    s_cmp_lt_u32 s35, 4000
    s_cbranch_scc1 M_second
    s_branch M_giveup
M_sg2:
    v_lshl_add_u32 v96, v96, 1, v95
    v_and_b32 v136, s39, v128
    v_cmpx_ne_u16 s[48:49], -1, v128
    v_lshrrev_b32_sdwa v184, v136, s97 dst_sel:DWORD dst_unused:UNUSED_PAD src0_sel:BYTE_1 src1_sel:DWORD
    v_or_b32_sdwa v136, v136, v184 dst_sel:DWORD dst_unused:UNUSED_PAD src0_sel:BYTE_3 src1_sel:BYTE_0
    v_perm_b32 v184, v96, v90, v92
    ds_add_rtn_u32 v136, v136, v243 offset:5120
    v_and_b32 v137, s39, v129
    v_cmpx_ne_u16 s[50:51], -1, v129
    v_lshrrev_b32_sdwa v185, v137, s97 dst_sel:DWORD dst_unused:UNUSED_PAD src0_sel:BYTE_1 src1_sel:DWORD
    v_or_b32_sdwa v137, v137, v185 dst_sel:DWORD dst_unused:UNUSED_PAD src0_sel:BYTE_3 src1_sel:BYTE_0
    v_perm_b32 v185, v96, v90, v93
    ds_add_rtn_u32 v137, v137, v243 offset:5120
    v_and_b32 v138, s39, v130
    v_cmpx_ne_u16 s[52:53], -1, v130
    v_lshrrev_b32_sdwa v186, v138, s97 dst_sel:DWORD dst_unused:UNUSED_PAD src0_sel:BYTE_1 src1_sel:DWORD
    v_or_b32_sdwa v138, v138, v186 dst_sel:DWORD dst_unused:UNUSED_PAD src0_sel:BYTE_3 src1_sel:BYTE_0
    v_perm_b32 v186, v96, v90, v94
    ds_add_rtn_u32 v138, v138, v243 offset:5120
    s_mov_b64 s[44:45], 0
    s_or_b32 s10, s52, s53
    s_waitcnt lgkmcnt(0)
    s_mov_b64 exec, s[48:49]
    ds_write2_b32 v136, v128, v184 offset1:1
    s_mov_b64 exec, s[50:51]
    ds_write2_b32 v137, v129, v185 offset1:1
    s_mov_b64 exec, s[52:53]
    ds_write2_b32 v138, v130, v186 offset1:1
    s_and_b32 s10, s10, 0x80808080
    s_waitcnt lgkmcnt(0)
    s_cbranch_scc1 M_giveup
M_se2:
    s_mov_b64 exec, s[46:47]
    s_cbranch_execz M_se3
    v_xor_b32 v96, s72, v135
    v_and_b32 v97, s73, v96
    v_cmp_ne_u32 vcc, 0, v97
    s_cbranch_vccz M_sg3
    buffer_load_dwordx4 v[132:135], v244, s[20:23], s67 offen sc1
    s_add_u32 s35, s35, 1
    s_cmp_lt_u32 s35, 4000
    s_cbranch_scc1 M_second
    s_branch M_giveup
M_sg3:
    v_lshl_add_u32 v96, v96, 1, v95
    v_and_b32 v136, s39, v132
    v_cmpx_ne_u16 s[48:49], -1, v132
    v_lshrrev_b32_sdwa v184, v136, s97 dst_sel:DWORD dst_unused:UNUSED_PAD src0_sel:BYTE_1 src1_sel:DWORD
    v_or_b32_sdwa v136, v136, v184 dst_sel:DWORD dst_unused:UNUSED_PAD src0_sel:BYTE_3 src1_sel:BYTE_0
    v_perm_b32 v184, v96, v91, v92
    ds_add_rtn_u32 v136, v136, v243 offset:5120
    v_and_b32 v137, s39, v133
    v_cmpx_ne_u16 s[50:51], -1, v133
    v_lshrrev_b32_sdwa v185, v137, s97 dst_sel:DWORD dst_unused:UNUSED_PAD src0_sel:BYTE_1 src1_sel:DWORD
    v_or_b32_sdwa v137, v137, v185 dst_sel:DWORD dst_unused:UNUSED_PAD src0_sel:BYTE_3 src1_sel:BYTE_0
    v_perm_b32 v185, v96, v91, v93
    ds_add_rtn_u32 v137, v137, v243 offset:5120
    v_and_b32 v138, s39, v134
    v_cmpx_ne_u16 s[52:53], -1, v134
    v_lshrrev_b32_sdwa v186, v138, s97 dst_sel:DWORD dst_unused:UNUSED_PAD src0_sel:BYTE_1 src1_sel:DWORD
    v_or_b32_sdwa v138, v138, v186 dst_sel:DWORD dst_unused:UNUSED_PAD src0_sel:BYTE_3 src1_sel:BYTE_0
    v_perm_b32 v186, v96, v91, v94
    ds_add_rtn_u32 v138, v138, v243 offset:5120
    s_mov_b64 s[46:47], 0
    s_or_b32 s10, s52, s53
    s_waitcnt lgkmcnt(0)
    s_mov_b64 exec, s[48:49]
    ds_write2_b32 v136, v132, v184 offset1:1
    s_mov_b64 exec, s[50:51]
    ds_write2_b32 v137, v133, v185 offset1:1
    s_mov_b64 exec, s[52:53]
    ds_write2_b32 v138, v134, v186 offset1:1
    s_and_b32 s10, s10, 0x80808080
    s_waitcnt lgkmcnt(0)
    s_cbranch_scc1 M_giveup
M_se3:
    s_branch M_routed
M_last:
.section .rodata,"a"
.p2align 6
.amdhsa_kernel gather_scatter__edge_featured_mpnn_egc__graph_kernel
  .amdhsa_next_free_vgpr 248
  .amdhsa_next_free_sgpr 102
  .amdhsa_accum_offset 248
  .amdhsa_group_segment_fixed_size 0
  .amdhsa_kernarg_size 80
  .amdhsa_user_sgpr_count 2
  .amdhsa_user_sgpr_kernarg_segment_ptr 1
  .amdhsa_system_sgpr_workgroup_id_x 1
.end_amdhsa_kernel
```
